```python
import torch

def _softmax(x, axis=-1):
    return torch.softmax(x, dim=axis)
def _gelu(x):
    return torch.nn.functional.gelu(x, approximate="tanh")
def _silu(x):
    return torch.nn.functional.silu(x)
def _sigmoid(x):
    return torch.sigmoid(x)
def _layernorm(x, axis=-1, eps=1e-5):
    m = x.mean(dim=axis, keepdim=True)
    v = x.var(dim=axis, keepdim=True, unbiased=False)
    return (x - m) / torch.sqrt(v + eps)
def _scatter_add(tgt, idx, src, axis=0):
    return tgt.clone().index_add_(axis, idx, src)
def _segment_sum(src, seg, n):
    out = torch.zeros((n,) + src.shape[1:], dtype=src.dtype)
    return out.index_add_(0, seg, src)
def _pad(x, pw):
    flat = tuple(v for pair in reversed(pw) for v in pair)
    return torch.nn.functional.pad(x, flat)

kernel_name = 'standalone__gqa_softmax__near_ridge'

def setup_inputs():

    _w = (lambda a: (lambda t: t.to(torch.bfloat16) if t.is_floating_point() else t)(torch.as_tensor(a)))
    B, Hq, Hkv, Sq, Sk, D = 8, 32, 16, 208, 2048, 128
    return {
        "q": _w((lambda *s: torch.randn(*s, dtype=torch.bfloat16) * 0.8)(B, Hq, Sq, D)),
        "k": _w((lambda *s: torch.randn(*s, dtype=torch.bfloat16) * 0.8)(B, Hkv, Sk, D)),
        "v": _w((lambda *s: torch.randn(*s, dtype=torch.bfloat16) * 0.05)(B, Hkv, Sk, D)),
    }

def reference(q, k, v):
    B, Hq, Sq, D = q.shape
    Hkv = k.shape[1]
    rep = Hq // Hkv
    k = (lambda x, n, axis: torch.repeat_interleave(x, n, dim=axis))(k, rep, axis=1)
    v = (lambda x, n, axis: torch.repeat_interleave(x, n, dim=axis))(v, rep, axis=1)
    scale = D ** -0.5
    scores = torch.einsum("bhqd,bhkd->bhqk", q, k) * scale
    p = _softmax(scores, axis=-1)
    return torch.einsum("bhqk,bhkd->bhqd", p, v)
```

```asm
; @launch grid=(256,1,1) block=(256,1,1) lds=151552
.amdgcn_target "amdgcn-amd-amdhsa--gfx950"
.text
.globl standalone__gqa_softmax__near_ridge_kernel
.p2align 8
.type standalone__gqa_softmax__near_ridge_kernel,@function
standalone__gqa_softmax__near_ridge_kernel:
    s_cmp_ge_u32 s2, 256
    s_cbranch_scc1 L_end
    s_load_dwordx4 s[32:35], s[0:1], 0
    s_load_dwordx4 s[36:39], s[0:1], 16
    s_getpc_b64 s[52:53]
L_pc:
    s_mov_b32 s54, L_fallback-L_pc
    s_mov_b32 s55, 0x00020000
    v_lshlrev_b32 v13, 7, v0
    buffer_load_dword v128, v13, s[52:55], 0 offen
    v_lshrrev_b32 v13, 6, v0
    v_and_b32 v0, 63, v0
    s_lshr_b32 s48, s2, 4
    v_readfirstlane_b32 s27, v13
    s_and_b32 s49, s2, 7
    s_lshl_b32 s48, s48, 3
    s_add_u32 s48, s48, s49
    s_bfe_u32 s49, s2, 0x10003
    s_lshl_b32 s50, s48, 1
    s_add_u32 s50, s50, s49
    s_mul_i32 s50, s50, 53248
    s_lshl_b32 s48, s48, 19
    s_lshr_b32 s28, s27, 1
    s_and_b32 s29, s27, 1
    s_mov_b32 s6, 53248
    s_mov_b32 s7, 0x00020000
    s_mov_b32 s11, 0x00020000
    v_bfe_u32 v15, v0, 2, 3
    v_lshrrev_b32 v13, 3, v0
    v_and_b32 v13, 2, v13
    v_and_b32 v14, 3, v0
    v_xor_b32 v13, v13, v14
    v_lshlrev_b32 v13, 4, v13
    v_lshl_add_u32 v3, v15, 8, v13
    v_lshrrev_b32 v15, 5, v0
    v_lshl_add_u32 v3, v15, 6, v3
    s_mul_i32 s40, s28, 0x6000
    s_lshl_b32 s52, s29, 12
    s_add_u32 s52, s52, s40
    s_add_u32 s53, s52, 0x2000
    s_add_u32 s54, s52, 0x4000
    s_lshl_b32 s59, s29, 11
    s_lshl_b32 s55, s28, 7
    s_add_u32 s55, s55, s59
    s_add_u32 s55, s55, 0xc000
    s_lshl_b32 s58, s29, 1
    s_add_u32 s58, s58, s28
    s_lshl_b32 s58, s58, 12
    s_lshr_b32 s56, s2, 4
    s_lshl_b32 s56, s56, 3
    s_and_b32 s57, s2, 7
    s_add_u32 s56, s56, s57
    s_mul_i32 s56, s56, 1
    s_and_b32 s56, s56, 31
    s_lshl_b32 s56, s56, 14
    s_add_u32 s21, s58, s56
    s_mov_b32 s22, s21
    s_mov_b32 s56, 0
    s_mov_b32 s57, 0
    s_mov_b32 s23, s58
    s_mov_b32 s10, 0x80000
    s_waitcnt lgkmcnt(0)
    s_add_u32 s4, s32, s50
    s_addc_u32 s5, s33, 0
    s_add_u32 s8, s34, s48
    s_addc_u32 s9, s35, 0
    buffer_load_dwordx4 v[16:19], v3, s[4:7], s52 offen offset:0
    buffer_load_dwordx4 v[20:23], v3, s[4:7], s52 offen offset:2048
    buffer_load_dwordx4 v[24:27], v3, s[4:7], s52 offen offset:128
    buffer_load_dwordx4 v[28:31], v3, s[4:7], s52 offen offset:2176
    buffer_load_dwordx4 v[112:115], v3, s[4:7], s55 offen
    s_mov_b32 m0, s23
    v_mov_b32 v221, 1.0
    buffer_load_dwordx4 v3, s[8:11], s21 offen offset:0 nt lds
    buffer_load_dwordx4 v3, s[8:11], s21 offen offset:2048 nt lds
    s_add_u32 m0, s23, 896
    v_mov_b32 v222, -1.0
    buffer_load_dwordx4 v3, s[8:11], s21 offen offset:128 nt lds
    buffer_load_dwordx4 v3, s[8:11], s21 offen offset:2176 nt lds
    s_add_u32 s21, s21, 0x4000
    s_add_u32 s56, s56, 0x4000
    s_xor_b32 s23, s23, 0x4000
    s_bitset0_b32 s21, 19
    s_andn2_b32 s10, 0x80000, s56
    buffer_load_dwordx4 v[48:51], v3, s[4:7], s53 offen offset:0
    buffer_load_dwordx4 v[52:55], v3, s[4:7], s53 offen offset:2048
    buffer_load_dwordx4 v[56:59], v3, s[4:7], s53 offen offset:128
    s_add_u32 s12, s36, s48
    s_addc_u32 s13, s37, 0
    s_load_dwordx16 s[76:91], s[12:13], 0
    s_add_u32 s16, s38, s50
    s_addc_u32 s17, s39, 0
    s_mov_b32 s48, 0x3e0293ee
    s_mov_b32 s49, s48
    s_mov_b32 s50, 0xffff0000
    s_mov_b64 s[30:31], 0
    s_mov_b32 s15, 0x00020000
    s_mov_b32 s18, 53248
    s_mov_b32 s19, 0x00020000
    v_bfe_u32 v15, v0, 1, 3
    v_and_b32 v13, 1, v0
    v_lshlrev_b32 v13, 4, v13
    v_lshl_add_u32 v12, v15, 8, v13
    v_lshrrev_b32 v15, 4, v0
    v_lshl_add_u32 v12, v15, 5, v12
    s_add_u32 s41, s40, 0x1000
    s_add_u32 s42, s40, 0x2000
    s_add_u32 s43, s40, 0x3000
    s_add_u32 s44, s40, 0x4000
    s_add_u32 s45, s40, 0x5000
    s_lshl_b32 s25, 0x4000, s28
    s_lshr_b32 s26, 0x8000, s28
    s_sub_u32 s47, s59, 1152
    s_lshl_b32 s51, s29, 10
    s_sub_u32 s24, s58, s51
    s_add_u32 s24, s24, 66560
    s_mov_b32 s14, 0x80000
    s_mov_b32 s20, 30
    v_and_b32 v15, 7, v0
    v_lshlrev_b32 v15, 6, v15
    v_bfe_u32 v13, v0, 3, 1
    v_lshl_add_u32 v15, v13, 11, v15
    v_lshrrev_b32 v13, 1, v0
    v_and_b32 v13, 2, v13
    v_lshrrev_b32 v14, 4, v0
    v_xor_b32 v13, v13, v14
    v_lshl_add_u32 v13, v13, 4, v15
    s_lshl_b32 s51, s29, 13
    v_add_u32 v1, s51, v13
    v_lshrrev_b32 v15, 5, v0
    v_and_b32 v14, 31, v0
    v_lshlrev_b32 v14, 3, v14
    v_lshl_add_u32 v15, v15, 11, v14
    s_add_u32 s51, s51, 65536
    v_add_u32 v2, s51, v15
    s_lshl_b32 s51, s28, 10
    s_add_u32 s59, s59, s51
    s_add_u32 s59, s59, 131072
    v_lshlrev_b32 v14, 4, v0
    v_add_u32 v217, s59, v14
    s_lshl_b32 s51, s27, 12
    s_add_u32 s51, s51, 98304
    v_add_u32 v216, s51, v14
    s_lshl_b32 s59, s28, 13
    s_add_u32 s59, s59, 98304
    v_add_u32 v218, s59, v13
    v_add_u32 v219, 131072, v13
    v_mov_b32 v4, 0
    v_mov_b32 v5, 0
    v_mov_b32 v6, 0
    v_mov_b32 v7, 0
    v_mov_b32 v8, 0
    v_mov_b32 v9, 0
    v_mov_b32 v10, 0
    v_and_b32 v252, 11, v0
    v_lshrrev_b32 v253, 5, v0
    v_cmp_eq_u32 vcc, v252, v253
    v_mov_b32 v15, 0x3f803f80
    v_bfe_u32 v14, v0, 2, 1
    v_cndmask_b32 v252, 0, v15, vcc
    v_cndmask_b32 v253, 0, v15, vcc
    v_cndmask_b32 v254, 0, v15, vcc
    v_cndmask_b32 v255, 0, v15, vcc
    v_mul_u32_u24 v14, 0xaaaa, v14
    v_add_u32 v14, 0x4444, v14
    v_mov_b32 v11, 0
    s_mul_i32 s100, s28, 0x3f800000
    s_xor_b32 s101, s100, 0x3f800000
    s_waitcnt lgkmcnt(0)
    v_add_f32 v220, |s76|, 0
    v_add_f32 v220, |s77|, v220
    v_add_f32 v220, |s78|, v220
    v_add_f32 v220, |s79|, v220
    v_add_f32 v220, |s80|, v220
    v_add_f32 v220, |s81|, v220
    v_add_f32 v220, |s82|, v220
    v_add_f32 v220, |s83|, v220
    v_add_f32 v220, |s84|, v220
    v_add_f32 v220, |s85|, v220
    v_add_f32 v220, |s86|, v220
    v_add_f32 v220, |s87|, v220
    v_add_f32 v220, |s88|, v220
    v_add_f32 v220, |s89|, v220
    v_add_f32 v220, |s90|, v220
    v_add_f32 v220, |s91|, v220
    s_nop 0
    v_readfirstlane_b32 s99, v220
    s_nop 0
    s_and_b32 s99, s99, 0x7f800000
    s_sub_u32 s99, s99, 0xa800000
    s_cselect_b32 s98, 0, -1
    s_add_u32 s99, s99, 0x102aaaab
    s_and_b32 s99, s99, s98
    s_and_b32 s98, s98, 8192
    v_mov_b32 v220, s99
    s_nop 1
    v_mfma_f32_16x16x1_4b_f32 a[16:31], v220, v222, 0
    v_mfma_f32_16x16x1_4b_f32 a[32:47], v220, v222, 0
    v_mfma_f32_16x16x1_4b_f32 a[48:63], v220, v222, 0
    v_mfma_f32_16x16x1_4b_f32 a[64:79], v220, v222, 0
    v_mfma_f32_16x16x1_4b_f32 a[80:95], v220, v222, 0
    v_mfma_f32_16x16x1_4b_f32 a[96:111], v220, v222, 0
    v_mfma_f32_16x16x1_4b_f32 a[0:15], v220, v222, 0
    v_mfma_f32_16x16x1_4b_f32 v[32:47], v220, v221, 0
    v_mfma_f32_16x16x1_4b_f32 v[64:79], v220, v221, 0
    v_mfma_f32_16x16x1_4b_f32 v[96:111], v220, v221, 0
    buffer_load_dwordx4 v[60:63], v3, s[4:7], s53 offen offset:2176
    s_waitcnt vmcnt(12)
    v_lshlrev_b32 v184, 16, v16
    v_and_b32 v185, s50, v16
    v_lshlrev_b32 v186, 16, v17
    v_and_b32 v187, s50, v17
    v_lshlrev_b32 v188, 16, v18
    v_and_b32 v189, s50, v18
    v_lshlrev_b32 v190, 16, v19
    v_and_b32 v191, s50, v19
    v_pk_mul_f32 v[184:185], v[184:185], s[48:49]
    v_pk_mul_f32 v[186:187], v[186:187], s[48:49]
    v_pk_mul_f32 v[188:189], v[188:189], s[48:49]
    v_pk_mul_f32 v[190:191], v[190:191], s[48:49]
    v_cvt_pk_bf16_f32 v16, v184, v185
    v_cvt_pk_bf16_f32 v17, v186, v187
    v_cvt_pk_bf16_f32 v18, v188, v189
    v_cvt_pk_bf16_f32 v19, v190, v191
    ds_write_b128 v216, v[16:19] offset:16384
    buffer_load_dwordx4 v[80:83], v3, s[4:7], s54 offen offset:0
    s_waitcnt vmcnt(12)
    v_lshlrev_b32 v192, 16, v20
    v_and_b32 v193, s50, v20
    v_lshlrev_b32 v194, 16, v21
    v_and_b32 v195, s50, v21
    v_lshlrev_b32 v196, 16, v22
    v_and_b32 v197, s50, v22
    v_lshlrev_b32 v198, 16, v23
    v_and_b32 v199, s50, v23
    v_pk_mul_f32 v[192:193], v[192:193], s[48:49]
    v_pk_mul_f32 v[194:195], v[194:195], s[48:49]
    v_pk_mul_f32 v[196:197], v[196:197], s[48:49]
    v_pk_mul_f32 v[198:199], v[198:199], s[48:49]
    v_cvt_pk_bf16_f32 v20, v192, v193
    v_cvt_pk_bf16_f32 v21, v194, v195
    v_cvt_pk_bf16_f32 v22, v196, v197
    v_cvt_pk_bf16_f32 v23, v198, v199
    ds_write_b128 v216, v[20:23] offset:18432
    buffer_load_dwordx4 v[84:87], v3, s[4:7], s54 offen offset:2048
    s_waitcnt vmcnt(12)
    v_lshlrev_b32 v200, 16, v24
    v_and_b32 v201, s50, v24
    v_lshlrev_b32 v202, 16, v25
    v_and_b32 v203, s50, v25
    v_lshlrev_b32 v204, 16, v26
    v_and_b32 v205, s50, v26
    v_lshlrev_b32 v206, 16, v27
    v_and_b32 v207, s50, v27
    v_pk_mul_f32 v[200:201], v[200:201], s[48:49]
    v_pk_mul_f32 v[202:203], v[202:203], s[48:49]
    v_pk_mul_f32 v[204:205], v[204:205], s[48:49]
    v_pk_mul_f32 v[206:207], v[206:207], s[48:49]
    v_cvt_pk_bf16_f32 v24, v200, v201
    v_cvt_pk_bf16_f32 v25, v202, v203
    v_cvt_pk_bf16_f32 v26, v204, v205
    v_cvt_pk_bf16_f32 v27, v206, v207
    ds_write_b128 v216, v[24:27] offset:17408
    buffer_load_dwordx4 v[88:91], v3, s[4:7], s54 offen offset:128
    s_waitcnt vmcnt(12)
    v_lshlrev_b32 v208, 16, v28
    v_and_b32 v209, s50, v28
    v_lshlrev_b32 v210, 16, v29
    v_and_b32 v211, s50, v29
    v_lshlrev_b32 v212, 16, v30
    v_and_b32 v213, s50, v30
    v_lshlrev_b32 v214, 16, v31
    v_and_b32 v215, s50, v31
    v_pk_mul_f32 v[208:209], v[208:209], s[48:49]
    v_pk_mul_f32 v[210:211], v[210:211], s[48:49]
    v_pk_mul_f32 v[212:213], v[212:213], s[48:49]
    v_pk_mul_f32 v[214:215], v[214:215], s[48:49]
    v_cvt_pk_bf16_f32 v28, v208, v209
    v_cvt_pk_bf16_f32 v29, v210, v211
    v_cvt_pk_bf16_f32 v30, v212, v213
    v_cvt_pk_bf16_f32 v31, v214, v215
    ds_write_b128 v216, v[28:31] offset:19456
    v_mfma_f32_16x16x1_4b_f32 v[16:31], v220, v221, 0
    buffer_load_dwordx4 v[92:95], v3, s[4:7], s54 offen offset:2176
    s_waitcnt vmcnt(12)
    v_lshlrev_b32 v184, 16, v112
    v_and_b32 v185, s50, v112
    v_lshlrev_b32 v186, 16, v113
    v_and_b32 v187, s50, v113
    v_lshlrev_b32 v188, 16, v114
    v_and_b32 v189, s50, v114
    v_lshlrev_b32 v190, 16, v115
    v_and_b32 v191, s50, v115
    v_pk_mul_f32 v[184:185], v[184:185], s[48:49]
    v_pk_mul_f32 v[186:187], v[186:187], s[48:49]
    v_pk_mul_f32 v[188:189], v[188:189], s[48:49]
    v_pk_mul_f32 v[190:191], v[190:191], s[48:49]
    v_cvt_pk_bf16_f32 v112, v184, v185
    v_cvt_pk_bf16_f32 v113, v186, v187
    v_cvt_pk_bf16_f32 v114, v188, v189
    v_cvt_pk_bf16_f32 v115, v190, v191
    ds_write_b128 v217, v[112:115] offset:0
    v_mfma_f32_16x16x1_4b_f32 v[112:127], v220, v221, 0
    s_mov_b32 m0, s23
    s_nop 0
    buffer_load_dwordx4 v3, s[8:11], s21 offen offset:0 nt lds
    buffer_load_dwordx4 v3, s[8:11], s21 offen offset:2048 nt lds
    s_add_u32 m0, s23, 896
    s_nop 0
    buffer_load_dwordx4 v3, s[8:11], s21 offen offset:128 nt lds
    buffer_load_dwordx4 v3, s[8:11], s21 offen offset:2176 nt lds
    s_add_u32 s21, s21, 0x4000
    s_add_u32 s56, s56, 0x4000
    s_xor_b32 s23, s23, 0x8000
    s_bitset0_b32 s21, 19
    s_andn2_b32 s10, 0x80000, s56
    s_waitcnt vmcnt(12)
    s_waitcnt lgkmcnt(0)
    s_barrier
    ds_read_b128 a[224:227], v1 offset:0
    ds_read_b128 a[112:115], v218 offset:16384
    ds_read_b128 a[240:243], v1 offset:4096
    s_mov_b32 m0, s24
    ds_read_b128 a[228:231], v1 offset:512
    ds_read_b128 a[116:119], v218 offset:16896
    buffer_load_dwordx4 v12, s[12:15], s22 offen offset:0 nt lds
    ds_read_b128 a[244:247], v1 offset:4608
    ds_read_b128 a[232:235], v1 offset:1024
    s_waitcnt vmcnt(12)
    v_lshlrev_b32 v192, 16, v48
    v_and_b32 v193, s50, v48
    v_lshlrev_b32 v194, 16, v49
    ds_read_b128 a[120:123], v218 offset:17408
    v_and_b32 v195, s50, v49
    v_lshlrev_b32 v196, 16, v50
    v_and_b32 v197, s50, v50
    ds_read_b128 a[248:251], v1 offset:5120
    v_lshlrev_b32 v198, 16, v51
    v_and_b32 v199, s50, v51
    v_pk_mul_f32 v[192:193], v[192:193], s[48:49]
    ds_read_b128 a[236:239], v1 offset:1536
    v_pk_mul_f32 v[194:195], v[194:195], s[48:49]
    v_pk_mul_f32 v[196:197], v[196:197], s[48:49]
    v_pk_mul_f32 v[198:199], v[198:199], s[48:49]
    ds_read_b128 a[124:127], v218 offset:17920
    v_cvt_pk_bf16_f32 v48, v192, v193
    v_cvt_pk_bf16_f32 v49, v194, v195
    v_cvt_pk_bf16_f32 v50, v196, v197
    ds_read_b128 a[252:255], v1 offset:5632
    v_cvt_pk_bf16_f32 v51, v198, v199
    ds_read_b128 a[128:131], v218 offset:20480
    s_waitcnt lgkmcnt(11)
    v_mfma_f32_16x16x32_bf16 v[128:131], a[224:227], a[112:115], 4.0
    ds_read_b128 a[132:135], v218 offset:20992
    s_waitcnt lgkmcnt(11)
    v_mfma_f32_16x16x32_bf16 v[156:159], a[240:243], a[112:115], 4.0
    ds_read_b128 a[136:139], v218 offset:21504
    ds_read_b128 a[140:143], v218 offset:22016
    s_waitcnt lgkmcnt(11)
    v_mfma_f32_16x16x32_bf16 v[128:131], a[228:231], a[116:119], v[128:131]
    ds_read_b128 a[208:211], v219 offset:0
    s_waitcnt lgkmcnt(11)
    v_mfma_f32_16x16x32_bf16 v[156:159], a[244:247], a[116:119], v[156:159]
    ds_read_b128 a[212:215], v219 offset:512
    ds_read_b128 a[216:219], v219 offset:1024
    s_waitcnt lgkmcnt(11)
    v_mfma_f32_16x16x32_bf16 v[128:131], a[232:235], a[120:123], v[128:131]
    buffer_load_dwordx4 v12, s[12:15], s22 offen offset:2048 nt lds
    ds_read_b128 a[220:223], v219 offset:1536
    s_waitcnt lgkmcnt(11)
    v_mfma_f32_16x16x32_bf16 v[156:159], a[248:251], a[120:123], v[156:159]
    ds_write_b128 v216, v[48:51] offset:36864
    s_waitcnt vmcnt(12)
    v_lshlrev_b32 v200, 16, v52
    v_and_b32 v201, s50, v52
    v_lshlrev_b32 v202, 16, v53
    v_and_b32 v203, s50, v53
    s_waitcnt lgkmcnt(10)
    v_mfma_f32_16x16x32_bf16 v[128:131], a[236:239], a[124:127], v[128:131]
    v_lshlrev_b32 v204, 16, v54
    v_and_b32 v205, s50, v54
    s_waitcnt lgkmcnt(9)
    v_mfma_f32_16x16x32_bf16 v[156:159], a[252:255], a[124:127], v[156:159]
    v_lshlrev_b32 v206, 16, v55
    v_and_b32 v207, s50, v55
    s_waitcnt lgkmcnt(8)
    v_mfma_f32_16x16x32_bf16 v[132:135], a[224:227], a[128:131], 4.0
    v_pk_mul_f32 v[200:201], v[200:201], s[48:49]
    v_pk_mul_f32 v[202:203], v[202:203], s[48:49]
    s_nop 1
    v_mfma_f32_16x16x32_bf16 v[160:163], a[240:243], a[128:131], 4.0
    v_pk_mul_f32 v[204:205], v[204:205], s[48:49]
    v_pk_mul_f32 v[206:207], v[206:207], s[48:49]
    s_waitcnt lgkmcnt(7)
    s_nop 0
    v_mfma_f32_16x16x32_bf16 v[132:135], a[228:231], a[132:135], v[132:135]
    v_cvt_pk_bf16_f32 v52, v200, v201
    v_cvt_pk_bf16_f32 v53, v202, v203
    v_mfma_f32_16x16x32_bf16 v[160:163], a[244:247], a[132:135], v[160:163]
    v_cvt_pk_bf16_f32 v54, v204, v205
    v_cvt_pk_bf16_f32 v55, v206, v207
    s_waitcnt lgkmcnt(6)
    v_mfma_f32_16x16x32_bf16 v[132:135], a[232:235], a[136:139], v[132:135]
    ds_write_b128 v216, v[52:55] offset:38912
    v_exp_f32 v128, v128
    v_mfma_f32_16x16x32_bf16 v[160:163], a[248:251], a[136:139], v[160:163]
    v_exp_f32 v129, v129
    s_waitcnt lgkmcnt(6)
    v_mfma_f32_16x16x32_bf16 v[132:135], a[236:239], a[140:143], v[132:135]
    v_exp_f32 v130, v130
    v_mfma_f32_16x16x32_bf16 v[160:163], a[252:255], a[140:143], v[160:163]
    v_exp_f32 v131, v131
    s_waitcnt lgkmcnt(5)
    v_mfma_f32_16x16x32_bf16 v[152:155], a[224:227], a[208:211], 4.0
    s_add_u32 m0, s24, s47
    s_waitcnt vmcnt(11)
    v_lshlrev_b32 v208, 16, v56
    buffer_load_dwordx4 v12, s[12:15], s22 offen offset:128 nt lds
    v_mfma_f32_16x16x32_bf16 v[180:183], a[240:243], a[208:211], 4.0
    v_and_b32 v209, s50, v56
    v_lshlrev_b32 v210, 16, v57
    s_waitcnt lgkmcnt(4)
    v_mfma_f32_16x16x32_bf16 v[152:155], a[228:231], a[212:215], v[152:155]
    v_and_b32 v211, s50, v57
    v_lshlrev_b32 v212, 16, v58
    v_mfma_f32_16x16x32_bf16 v[180:183], a[244:247], a[212:215], v[180:183]
    v_and_b32 v213, s50, v58
    v_lshlrev_b32 v214, 16, v59
    s_waitcnt lgkmcnt(3)
    v_mfma_f32_16x16x32_bf16 v[152:155], a[232:235], a[216:219], v[152:155]
    v_and_b32 v215, s50, v59
    v_pk_mul_f32 v[208:209], v[208:209], s[48:49]
    s_nop 1
    v_mfma_f32_16x16x32_bf16 v[180:183], a[248:251], a[216:219], v[180:183]
    v_pk_mul_f32 v[210:211], v[210:211], s[48:49]
    v_pk_mul_f32 v[212:213], v[212:213], s[48:49]
    s_waitcnt lgkmcnt(2)
    s_nop 0
    v_mfma_f32_16x16x32_bf16 v[152:155], a[236:239], a[220:223], v[152:155]
    v_pk_mul_f32 v[214:215], v[214:215], s[48:49]
    v_cvt_pk_bf16_f32 v56, v208, v209
    s_nop 0
    v_mfma_f32_16x16x32_bf16 v[180:183], a[252:255], a[220:223], v[180:183]
    v_cvt_pk_bf16_f32 v57, v210, v211
    v_cvt_pk_bf16_f32 v58, v212, v213
    v_cvt_pk_bf16_f32 v59, v214, v215
    ds_write_b128 v216, v[56:59] offset:37888
    v_exp_f32 v156, v156
    v_exp_f32 v157, v157
    v_exp_f32 v158, v158
    v_exp_f32 v159, v159
    v_fmac_f32 v4, s100, v129
    v_fmac_f32 v4, s100, v130
    v_fmac_f32 v4, s100, v131
    v_fmac_f32 v4, s100, v128
    v_fmac_f32 v4, s100, v156
    v_fmac_f32 v4, s100, v157
    v_fmac_f32 v4, s100, v158
    v_fmac_f32 v4, s100, v159
    v_exp_f32 v132, v132
    v_exp_f32 v133, v133
    v_exp_f32 v134, v134
    buffer_load_dwordx4 v12, s[12:15], s22 offen offset:2176 nt lds
    s_add_u32 s22, s22, 0x4000
    s_add_u32 s57, s57, 0x4000
    s_xor_b32 s24, s24, 0x4000
    s_bitset0_b32 s22, 19
    s_andn2_b32 s14, 0x80000, s57
    s_waitcnt vmcnt(12)
    v_lshlrev_b32 v184, 16, v60
    v_and_b32 v185, s50, v60
    v_lshlrev_b32 v186, 16, v61
    v_and_b32 v187, s50, v61
    v_lshlrev_b32 v188, 16, v62
    v_and_b32 v189, s50, v62
    v_lshlrev_b32 v190, 16, v63
    v_and_b32 v191, s50, v63
    v_pk_mul_f32 v[184:185], v[184:185], s[48:49]
    v_pk_mul_f32 v[186:187], v[186:187], s[48:49]
    v_pk_mul_f32 v[188:189], v[188:189], s[48:49]
    v_pk_mul_f32 v[190:191], v[190:191], s[48:49]
    v_cvt_pk_bf16_f32 v60, v184, v185
    v_cvt_pk_bf16_f32 v61, v186, v187
    v_cvt_pk_bf16_f32 v62, v188, v189
    v_cvt_pk_bf16_f32 v63, v190, v191
    ds_write_b128 v216, v[60:63] offset:39936
    v_mfma_f32_16x16x1_4b_f32 v[48:63], v220, v221, 0
    v_exp_f32 v135, v135
    v_exp_f32 v160, v160
    v_exp_f32 v161, v161
    v_exp_f32 v162, v162
    v_exp_f32 v163, v163
    v_add_f32 v5, v132, v5
    v_add_f32 v5, v133, v5
    v_add_f32 v5, v134, v5
    v_add_f32 v5, v135, v5
    v_fmac_f32 v5, s100, v160
    v_fmac_f32 v5, s100, v161
    v_fmac_f32 v5, s100, v162
    v_fmac_f32 v5, s100, v163
    s_mov_b32 m0, s24
    s_nop 0
    buffer_load_dwordx4 v12, s[12:15], s22 offen offset:0 nt lds
    s_waitcnt vmcnt(12)
    v_lshlrev_b32 v192, 16, v80
    v_and_b32 v193, s50, v80
    v_lshlrev_b32 v194, 16, v81
    v_and_b32 v195, s50, v81
    v_lshlrev_b32 v196, 16, v82
    v_and_b32 v197, s50, v82
    v_lshlrev_b32 v198, 16, v83
    s_waitcnt lgkmcnt(0)
    s_barrier
    v_and_b32 v199, s50, v83
    v_pk_mul_f32 v[192:193], v[192:193], s[48:49]
    v_pk_mul_f32 v[194:195], v[194:195], s[48:49]
    v_pk_mul_f32 v[196:197], v[196:197], s[48:49]
    v_pk_mul_f32 v[198:199], v[198:199], s[48:49]
    v_cvt_pk_bf16_f32 v80, v192, v193
    v_cvt_pk_bf16_f32 v81, v194, v195
    v_cvt_pk_bf16_f32 v82, v196, v197
    v_cvt_pk_bf16_f32 v83, v198, v199
    ds_write_b128 v216, v[80:83] offset:0
    ds_read_b128 a[144:147], v218 offset:36864
    ds_read_b128 a[148:151], v218 offset:37376
    ds_read_b128 a[152:155], v218 offset:37888
    ds_read_b128 a[156:159], v218 offset:38400
    ds_read_b128 a[160:163], v218 offset:40960
    ds_read_b128 a[164:167], v218 offset:41472
    ds_read_b128 a[168:171], v218 offset:41984
    ds_read_b128 a[172:175], v218 offset:42496
    buffer_load_dwordx4 v12, s[12:15], s22 offen offset:2048 nt lds
    s_waitcnt vmcnt(12)
    v_lshlrev_b32 v200, 16, v84
    v_and_b32 v201, s50, v84
    v_lshlrev_b32 v202, 16, v85
    v_and_b32 v203, s50, v85
    v_lshlrev_b32 v204, 16, v86
    v_and_b32 v205, s50, v86
    v_lshlrev_b32 v206, 16, v87
    s_waitcnt lgkmcnt(7)
    v_mfma_f32_16x16x32_bf16 v[136:139], a[224:227], a[144:147], 4.0
    v_and_b32 v207, s50, v87
    v_pk_mul_f32 v[200:201], v[200:201], s[48:49]
    s_nop 1
    v_mfma_f32_16x16x32_bf16 v[164:167], a[240:243], a[144:147], 4.0
    v_pk_mul_f32 v[202:203], v[202:203], s[48:49]
    v_pk_mul_f32 v[204:205], v[204:205], s[48:49]
    s_waitcnt lgkmcnt(6)
    s_nop 0
    v_mfma_f32_16x16x32_bf16 v[136:139], a[228:231], a[148:151], v[136:139]
    v_pk_mul_f32 v[206:207], v[206:207], s[48:49]
    v_cvt_pk_bf16_f32 v84, v200, v201
    s_nop 0
    v_mfma_f32_16x16x32_bf16 v[164:167], a[244:247], a[148:151], v[164:167]
    v_cvt_pk_bf16_f32 v85, v202, v203
    v_cvt_pk_bf16_f32 v86, v204, v205
    s_waitcnt lgkmcnt(5)
    v_mfma_f32_16x16x32_bf16 v[136:139], a[232:235], a[152:155], v[136:139]
    v_cvt_pk_bf16_f32 v87, v206, v207
    ds_write_b128 v216, v[84:87] offset:2048
    v_mfma_f32_16x16x32_bf16 v[164:167], a[248:251], a[152:155], v[164:167]
    s_waitcnt lgkmcnt(5)
    v_mfma_f32_16x16x32_bf16 v[136:139], a[236:239], a[156:159], v[136:139]
    v_mfma_f32_16x16x32_bf16 v[164:167], a[252:255], a[156:159], v[164:167]
    s_waitcnt lgkmcnt(4)
    v_mfma_f32_16x16x32_bf16 v[140:143], a[224:227], a[160:163], 4.0
    s_nop 4
    v_exp_f32 v136, v136
    v_mfma_f32_16x16x32_bf16 v[168:171], a[240:243], a[160:163], 4.0
    v_exp_f32 v137, v137
    s_waitcnt lgkmcnt(3)
    v_mfma_f32_16x16x32_bf16 v[140:143], a[228:231], a[164:167], v[140:143]
    v_exp_f32 v138, v138
    s_add_u32 m0, s24, s47
    v_mfma_f32_16x16x32_bf16 v[168:171], a[244:247], a[164:167], v[168:171]
    buffer_load_dwordx4 v12, s[12:15], s22 offen offset:128 nt lds
    s_waitcnt lgkmcnt(2)
    v_mfma_f32_16x16x32_bf16 v[140:143], a[232:235], a[168:171], v[140:143]
    s_waitcnt vmcnt(12)
    v_lshlrev_b32 v208, 16, v88
    v_and_b32 v209, s50, v88
    v_mfma_f32_16x16x32_bf16 v[168:171], a[248:251], a[168:171], v[168:171]
    v_lshlrev_b32 v210, 16, v89
    v_and_b32 v211, s50, v89
    s_waitcnt lgkmcnt(1)
    v_mfma_f32_16x16x32_bf16 v[140:143], a[236:239], a[172:175], v[140:143]
    v_lshlrev_b32 v212, 16, v90
    v_and_b32 v213, s50, v90
    v_mfma_f32_16x16x32_bf16 v[168:171], a[252:255], a[172:175], v[168:171]
    v_lshlrev_b32 v214, 16, v91
    v_and_b32 v215, s50, v91
    v_pk_mul_f32 v[208:209], v[208:209], s[48:49]
    v_pk_mul_f32 v[210:211], v[210:211], s[48:49]
    v_pk_mul_f32 v[212:213], v[212:213], s[48:49]
    v_pk_mul_f32 v[214:215], v[214:215], s[48:49]
    v_cvt_pk_bf16_f32 v88, v208, v209
    v_cvt_pk_bf16_f32 v89, v210, v211
    v_cvt_pk_bf16_f32 v90, v212, v213
    v_cvt_pk_bf16_f32 v91, v214, v215
    ds_write_b128 v216, v[88:91] offset:1024
    v_exp_f32 v139, v139
    v_exp_f32 v164, v164
    v_exp_f32 v165, v165
    v_exp_f32 v166, v166
    v_exp_f32 v167, v167
    v_fmac_f32 v6, s100, v136
    v_fmac_f32 v6, s100, v137
    v_fmac_f32 v6, s100, v138
    v_fmac_f32 v6, s100, v139
    v_fmac_f32 v6, s100, v164
    v_fmac_f32 v6, s100, v165
    v_fmac_f32 v6, s100, v166
    v_fmac_f32 v6, s100, v167
    v_exp_f32 v140, v140
    v_exp_f32 v141, v141
    v_exp_f32 v142, v142
    v_exp_f32 v143, v143
    buffer_load_dwordx4 v12, s[12:15], s22 offen offset:2176 nt lds
    s_add_u32 s22, s22, 0x4000
    s_add_u32 s57, s57, 0x4000
    s_xor_b32 s24, s24, 0x8000
    s_bitset0_b32 s22, 19
    s_andn2_b32 s14, 0x80000, s57
    s_waitcnt vmcnt(12)
    v_lshlrev_b32 v184, 16, v92
    v_and_b32 v185, s50, v92
    v_lshlrev_b32 v186, 16, v93
    v_and_b32 v187, s50, v93
    v_lshlrev_b32 v188, 16, v94
    v_and_b32 v189, s50, v94
    v_lshlrev_b32 v190, 16, v95
    v_and_b32 v191, s50, v95
    v_pk_mul_f32 v[184:185], v[184:185], s[48:49]
    v_pk_mul_f32 v[186:187], v[186:187], s[48:49]
    v_pk_mul_f32 v[188:189], v[188:189], s[48:49]
    v_pk_mul_f32 v[190:191], v[190:191], s[48:49]
    v_cvt_pk_bf16_f32 v92, v184, v185
    v_cvt_pk_bf16_f32 v93, v186, v187
    v_cvt_pk_bf16_f32 v94, v188, v189
    v_cvt_pk_bf16_f32 v95, v190, v191
    ds_write_b128 v216, v[92:95] offset:3072
    v_mfma_f32_16x16x1_4b_f32 v[80:95], v220, v221, 0
    v_exp_f32 v168, v168
    v_exp_f32 v169, v169
    v_exp_f32 v170, v170
    v_exp_f32 v171, v171
    v_add_f32 v7, v140, v7
    v_add_f32 v7, v141, v7
    v_add_f32 v7, v142, v7
    v_add_f32 v7, v143, v7
    v_fmac_f32 v7, s100, v168
    s_mov_b32 m0, s23
    s_nop 0
    buffer_load_dwordx4 v3, s[8:11], s21 offen offset:0 nt lds
    s_waitcnt lgkmcnt(0)
    s_barrier
    ds_read_b128 a[176:179], v218 offset:0
    ds_read_b128 a[180:183], v218 offset:512
    ds_read_b128 a[184:187], v218 offset:1024
    ds_read_b128 a[188:191], v218 offset:1536
    buffer_load_dwordx4 v3, s[8:11], s21 offen offset:2048 nt lds
    ds_read_b128 a[192:195], v218 offset:4096
    ds_read_b128 a[196:199], v218 offset:4608
    ds_read_b128 a[200:203], v218 offset:5120
    ds_read_b128 a[204:207], v218 offset:5632
    s_add_u32 m0, s23, 896
    s_nop 0
    buffer_load_dwordx4 v3, s[8:11], s21 offen offset:128 nt lds
    s_waitcnt lgkmcnt(7)
    v_mfma_f32_16x16x32_bf16 v[144:147], a[224:227], a[176:179], 4.0
    v_mfma_f32_16x16x32_bf16 v[172:175], a[240:243], a[176:179], 4.0
    s_waitcnt lgkmcnt(6)
    v_mfma_f32_16x16x32_bf16 v[144:147], a[228:231], a[180:183], v[144:147]
    v_mfma_f32_16x16x32_bf16 v[172:175], a[244:247], a[180:183], v[172:175]
    s_waitcnt lgkmcnt(5)
    v_mfma_f32_16x16x32_bf16 v[144:147], a[232:235], a[184:187], v[144:147]
    v_mfma_f32_16x16x32_bf16 v[172:175], a[248:251], a[184:187], v[172:175]
    s_waitcnt lgkmcnt(4)
    v_mfma_f32_16x16x32_bf16 v[144:147], a[236:239], a[188:191], v[144:147]
    buffer_load_dwordx4 v3, s[8:11], s21 offen offset:2176 nt lds
    s_add_u32 s21, s21, 0x4000
    s_add_u32 s56, s56, 0x4000
    s_xor_b32 s23, s23, 0x4000
    s_bitset0_b32 s21, 19
    s_andn2_b32 s10, 0x80000, s56
    v_mfma_f32_16x16x32_bf16 v[172:175], a[252:255], a[188:191], v[172:175]
    s_nop 0
    v_exp_f32 v144, v144
    s_waitcnt lgkmcnt(3)
    v_mfma_f32_16x16x32_bf16 v[148:151], a[224:227], a[192:195], 4.0
    v_exp_f32 v145, v145
    v_mfma_f32_16x16x32_bf16 v[176:179], a[240:243], a[192:195], 4.0
    v_exp_f32 v146, v146
    s_waitcnt lgkmcnt(2)
    v_mfma_f32_16x16x32_bf16 v[148:151], a[228:231], a[196:199], v[148:151]
    v_exp_f32 v147, v147
    v_mfma_f32_16x16x32_bf16 v[176:179], a[244:247], a[196:199], v[176:179]
    v_exp_f32 v172, v172
    s_waitcnt lgkmcnt(1)
    v_mfma_f32_16x16x32_bf16 v[148:151], a[232:235], a[200:203], v[148:151]
    v_exp_f32 v173, v173
    v_mfma_f32_16x16x32_bf16 v[176:179], a[248:251], a[200:203], v[176:179]
    v_exp_f32 v174, v174
    s_waitcnt lgkmcnt(0)
    v_mfma_f32_16x16x32_bf16 v[148:151], a[236:239], a[204:207], v[148:151]
    v_exp_f32 v175, v175
    v_mfma_f32_16x16x32_bf16 v[176:179], a[252:255], a[204:207], v[176:179]
    v_fmac_f32 v8, s100, v144
    v_fmac_f32 v8, s100, v145
    v_fmac_f32 v8, s100, v146
    v_fmac_f32 v8, s100, v147
    s_nop 1
    v_exp_f32 v148, v148
    v_exp_f32 v149, v149
    v_exp_f32 v150, v150
    v_exp_f32 v151, v151
    v_exp_f32 v176, v176
    v_add_f32 v9, v148, v9
    v_add_f32 v9, v149, v9
    v_add_f32 v9, v150, v9
    v_add_f32 v9, v151, v9
L_join:
    s_cmp_lg_u32 s28, 0
    s_cbranch_scc1 L_pro1
    s_nop 7
    s_mov_b32 m0, s24
    s_nop 0
    buffer_load_dwordx4 v12, s[12:15], s22 offen offset:0 nt lds
    buffer_load_dwordx4 v12, s[12:15], s22 offen offset:2048 nt lds
    s_add_u32 m0, s24, s47
    s_nop 0
    buffer_load_dwordx4 v12, s[12:15], s22 offen offset:128 nt lds
    buffer_load_dwordx4 v12, s[12:15], s22 offen offset:2176 nt lds
    s_add_u32 s22, s22, 0x4000
    s_add_u32 s57, s57, 0x4000
    s_xor_b32 s24, s24, s25
    s_bitset0_b32 s22, 19
    s_andn2_b32 s14, 0x80000, s57
    v_cvt_pk_bf16_f32 v188, v128, v129
    v_cvt_pk_bf16_f32 v189, v130, v131
    v_cvt_pk_bf16_f32 v194, v132, v133
    v_cvt_pk_bf16_f32 v195, v134, v135
    v_xor_b32 v1, s25, v1
    v_cvt_pk_bf16_f32 v200, v136, v137
    v_cvt_pk_bf16_f32 v201, v138, v139
    v_exp_f32 v152, v152
    v_cvt_pk_bf16_f32 v206, v140, v141
    v_exp_f32 v153, v153
    v_cvt_pk_bf16_f32 v207, v142, v143
    v_exp_f32 v154, v154
    v_exp_f32 v155, v155
    v_cvt_pk_bf16_f32 v212, v144, v145
    v_cvt_pk_bf16_f32 v213, v146, v147
    v_cvt_pk_bf16_f32 v218, v148, v149
    v_cvt_pk_bf16_f32 v219, v150, v151
    v_cvt_pk_bf16_f32 v222, v152, v153
    v_cvt_pk_bf16_f32 v223, v154, v155
    v_add_f32 v10, v152, v10
    v_add_f32 v10, v153, v10
    v_add_f32 v10, v154, v10
    v_add_f32 v10, v155, v10
    v_cvt_pk_bf16_f32 v186, v156, v157
    v_exp_f32 v177, v177
    s_waitcnt vmcnt(12) lgkmcnt(0)
    s_barrier
    s_mov_b32 m0, s23
    ds_read_b128 a[224:227], v1 offset:0
    buffer_load_dwordx4 v3, s[8:11], s21 offen offset:0 nt lds
    ds_read_b128 a[228:231], v1 offset:512
    ds_read_b128 a[232:235], v1 offset:1024
    buffer_load_dwordx4 v3, s[8:11], s21 offen offset:2048 nt lds
    ds_read_b128 a[236:239], v1 offset:1536
    s_add_u32 m0, s23, 896
    s_nop 0
    buffer_load_dwordx4 v3, s[8:11], s21 offen offset:128 nt lds
    buffer_load_dwordx4 v3, s[8:11], s21 offen offset:2176 nt lds
    s_cmp_lg_u32 s30, 0
    s_waitcnt lgkmcnt(0)

    s_cbranch_scc0 L_A
    s_branch L_Af
L_pro1:
    s_nop 7
    s_mov_b32 m0, s24
    s_nop 0
    buffer_load_dwordx4 v12, s[12:15], s22 offen offset:0 nt lds
    buffer_load_dwordx4 v12, s[12:15], s22 offen offset:2048 nt lds
    s_add_u32 m0, s24, s47
    s_nop 0
    buffer_load_dwordx4 v12, s[12:15], s22 offen offset:128 nt lds
    buffer_load_dwordx4 v12, s[12:15], s22 offen offset:2176 nt lds
    s_add_u32 s22, s22, 0x4000
    s_add_u32 s57, s57, 0x4000
    s_xor_b32 s24, s24, s26
    s_bitset0_b32 s22, 19
    s_andn2_b32 s14, 0x80000, s57
    v_cvt_pk_bf16_f32 v185, v130, v131
    v_cvt_pk_bf16_f32 v190, v132, v133
    v_cvt_pk_bf16_f32 v191, v134, v135
    v_cvt_pk_bf16_f32 v196, v136, v137
    v_cvt_pk_bf16_f32 v197, v138, v139
    v_cvt_pk_bf16_f32 v202, v140, v141
    v_cvt_pk_bf16_f32 v203, v142, v143
    v_xor_b32 v1, s26, v1
    v_cvt_pk_bf16_f32 v208, v144, v145
    v_cvt_pk_bf16_f32 v209, v146, v147
    v_cvt_pk_bf16_f32 v214, v148, v149
    v_cvt_pk_bf16_f32 v184, v128, v129
    v_cvt_pk_bf16_f32 v215, v150, v151
    v_cvt_pk_bf16_f32 v186, v156, v157
    v_cvt_pk_bf16_f32 v187, v158, v159
    v_cvt_pk_bf16_f32 v192, v160, v161
    v_cvt_pk_bf16_f32 v193, v162, v163
    v_cvt_pk_bf16_f32 v198, v164, v165
    s_waitcnt vmcnt(12) lgkmcnt(0)
    s_barrier
    s_mov_b32 m0, s23
    s_nop 0
    buffer_load_dwordx4 v3, s[8:11], s21 offen offset:0 nt lds
    ds_read_b128 a[224:227], v1 offset:0
    buffer_load_dwordx4 v3, s[8:11], s21 offen offset:2048 nt lds
    ds_read_b128 a[228:231], v1 offset:512
    s_add_u32 m0, s23, 896
    ds_read_b128 a[232:235], v1 offset:1024
    buffer_load_dwordx4 v3, s[8:11], s21 offen offset:128 nt lds
    ds_read_b128 a[236:239], v1 offset:1536
    buffer_load_dwordx4 v3, s[8:11], s21 offen offset:2176 nt lds
    s_cmp_lg_u32 s30, 0
    s_waitcnt lgkmcnt(0)

    s_cbranch_scc0 L_B
    s_branch L_Bf
.p2align 6
L_A:
    s_waitcnt lgkmcnt(3)
    v_mfma_f32_16x16x32_bf16 v[128:131], a[224:227], a[112:115], 4.0
    s_waitcnt lgkmcnt(2)
    v_exp_f32 v178, v178
    v_mfma_f32_16x16x32_bf16 v[128:131], a[228:231], a[116:119], v[128:131]
    s_waitcnt lgkmcnt(1)
    ds_read_b64_tr_b16 a[242:243], v2 offset:0
    v_cvt_pk_bf16_f32 v193, v162, v163
    v_mfma_f32_16x16x32_bf16 v[128:131], a[232:235], a[120:123], v[128:131]
    s_waitcnt lgkmcnt(1)
    v_exp_f32 v179, v179
    v_mfma_f32_16x16x32_bf16 v[128:131], a[236:239], a[124:127], v[128:131]
    s_add_u32 s21, s21, 0x4000
    ds_read_b64_tr_b16 a[240:241], v2 offset:4096
    v_cvt_pk_bf16_f32 v198, v164, v165
    v_mfma_f32_16x16x32_bf16 v[132:135], a[236:239], a[140:143], 4.0
    s_add_u32 s56, s56, 0x4000
    v_exp_f32 v180, v180
    v_mfma_f32_16x16x32_bf16 v[132:135], a[232:235], a[136:139], v[132:135]
    s_xor_b32 s23, s23, s26
    ds_read_b64_tr_b16 a[246:247], v2 offset:256
    v_cvt_pk_bf16_f32 v187, v158, v159
    v_mfma_f32_16x16x32_bf16 v[132:135], a[228:231], a[132:135], v[132:135]
    s_bitset0_b32 s21, 19
    v_exp_f32 v181, v181
    v_mfma_f32_16x16x32_bf16 v[132:135], a[224:227], a[128:131], v[132:135]
    s_andn2_b32 s10, 0x80000, s56
    v_exp_f32 v182, v182
    v_mfma_f32_16x16x32_bf16 v[136:139], a[224:227], a[144:147], 4.0
    ds_read_b64_tr_b16 a[244:245], v2 offset:4352
    v_cvt_pk_bf16_f32 v192, v160, v161
    v_mfma_f32_16x16x32_bf16 v[136:139], a[228:231], a[148:151], v[136:139]
    v_exp_f32 v183, v183
    v_mfma_f32_16x16x32_bf16 v[136:139], a[232:235], a[152:155], v[136:139]
    ds_read_b64_tr_b16 a[250:251], v2 offset:512
    v_cvt_pk_bf16_f32 v221, v182, v183
    v_mfma_f32_16x16x32_bf16 v[136:139], a[236:239], a[156:159], v[136:139]
    v_exp_f32 v128, v128
    v_mfma_f32_16x16x32_bf16 v[140:143], a[236:239], a[172:175], 4.0
    v_cvt_pk_bf16_f32 v199, v166, v167
    v_cvt_pk_bf16_f32 v220, v180, v181
    v_mfma_f32_16x16x32_bf16 v[140:143], a[232:235], a[168:171], v[140:143]
    ds_read_b64_tr_b16 a[248:249], v2 offset:4608
    v_cvt_pk_bf16_f32 v204, v168, v169
    v_mfma_f32_16x16x32_bf16 v[140:143], a[228:231], a[164:167], v[140:143]
    v_exp_f32 v129, v129
    v_mfma_f32_16x16x32_bf16 v[140:143], a[224:227], a[160:163], v[140:143]
    ds_read_b64_tr_b16 a[254:255], v2 offset:768
    v_cvt_pk_bf16_f32 v205, v170, v171
    v_mfma_f32_16x16x32_bf16 v[144:147], a[224:227], a[176:179], 4.0
    v_exp_f32 v130, v130
    v_mfma_f32_16x16x32_bf16 v[144:147], a[228:231], a[180:183], v[144:147]
    ds_read_b64_tr_b16 a[252:253], v2 offset:4864
    v_add_f32 v4, v129, v4
    v_mfma_f32_16x16x32_bf16 v[144:147], a[232:235], a[184:187], v[144:147]
    v_exp_f32 v131, v131
    v_mfma_f32_16x16x32_bf16 v[144:147], a[236:239], a[188:191], v[144:147]
    v_exp_f32 v132, v132
    v_mfma_f32_16x16x32_bf16 v[148:151], a[236:239], a[204:207], 4.0
    v_add_f32 v4, v130, v4
    v_cvt_pk_bf16_f32 v185, v130, v131
    v_mfma_f32_16x16x32_bf16 v[148:151], a[232:235], a[200:203], v[148:151]
    v_exp_f32 v133, v133
    v_mfma_f32_16x16x32_bf16 v[148:151], a[228:231], a[196:199], v[148:151]
    v_cvt_pk_bf16_f32 v190, v132, v133
    v_add_f32 v4, v131, v4
    v_mfma_f32_16x16x32_bf16 v[148:151], a[224:227], a[192:195], v[148:151]
    s_waitcnt lgkmcnt(6)
    v_exp_f32 v134, v134
    v_mfma_f32_16x16x32_bf16 a[0:3], a[240:243], v[186:189], a[0:3]
    s_waitcnt lgkmcnt(4)
    v_cvt_pk_bf16_f32 v210, v172, v173
    v_cvt_pk_bf16_f32 v211, v174, v175
    v_mfma_f32_16x16x32_bf16 a[4:7], a[244:247], v[186:189], a[4:7]
    s_mov_b32 m0, s24
    v_exp_f32 v135, v135
    v_mfma_f32_16x16x32_bf16 a[16:19], a[240:243], v[192:195], a[16:19]
    buffer_load_dwordx4 v12, s[12:15], s22 offen offset:0 nt lds
    v_mfma_f32_16x16x32_bf16 a[20:23], a[244:247], v[192:195], a[20:23]
    v_cvt_pk_bf16_f32 v191, v134, v135
    v_cvt_pk_bf16_f32 v216, v176, v177
    v_mfma_f32_16x16x32_bf16 a[32:35], a[240:243], v[198:201], a[32:35]
    ds_read_b128 a[224:227], v1 offset:4096
    v_cvt_pk_bf16_f32 v217, v178, v179
    v_mfma_f32_16x16x32_bf16 a[36:39], a[244:247], v[198:201], a[36:39]
    v_exp_f32 v136, v136
    v_mfma_f32_16x16x32_bf16 a[48:51], a[240:243], v[204:207], a[48:51]
    v_exp_f32 v137, v137
    v_mfma_f32_16x16x32_bf16 a[52:55], a[244:247], v[204:207], a[52:55]
    v_add_f32 v6, v136, v6
    v_cvt_pk_bf16_f32 v196, v136, v137
    v_mfma_f32_16x16x32_bf16 a[64:67], a[240:243], v[210:213], a[64:67]
    ds_read_b128 a[228:231], v1 offset:4608
    v_add_f32 v6, v137, v6
    v_mfma_f32_16x16x32_bf16 a[68:71], a[244:247], v[210:213], a[68:71]
    buffer_load_dwordx4 v12, s[12:15], s22 offen offset:2048 nt lds
    v_mfma_f32_16x16x32_bf16 a[80:83], a[240:243], v[216:219], a[80:83]
    v_exp_f32 v138, v138
    v_mfma_f32_16x16x32_bf16 a[84:87], a[244:247], v[216:219], a[84:87]
    v_exp_f32 v139, v139
    v_mfma_f32_16x16x32_bf16 a[96:99], a[240:243], v[220:223], a[96:99]
    v_exp_f32 v140, v140
    v_mfma_f32_16x16x32_bf16 a[100:103], a[244:247], v[220:223], a[100:103]
    s_waitcnt lgkmcnt(4)
    v_add_f32 v6, v138, v6
    v_cvt_pk_bf16_f32 v197, v138, v139
    v_mfma_f32_16x16x32_bf16 a[104:107], a[248:251], v[220:223], a[104:107]
    s_waitcnt lgkmcnt(2)
    ds_read_b128 a[232:235], v1 offset:5120
    v_add_f32 v6, v139, v6
    v_mfma_f32_16x16x32_bf16 a[108:111], a[252:255], v[220:223], a[108:111]
    s_add_u32 m0, s24, s47
    v_exp_f32 v141, v141
    v_mfma_f32_16x16x32_bf16 a[88:91], a[248:251], v[216:219], a[88:91]
    buffer_load_dwordx4 v12, s[12:15], s22 offen offset:128 nt lds
    v_mfma_f32_16x16x32_bf16 a[92:95], a[252:255], v[216:219], a[92:95]
    v_exp_f32 v142, v142
    v_mfma_f32_16x16x32_bf16 a[72:75], a[248:251], v[210:213], a[72:75]
    v_exp_f32 v143, v143
    v_mfma_f32_16x16x32_bf16 a[76:79], a[252:255], v[210:213], a[76:79]
    ds_read_b128 a[236:239], v1 offset:5632
    v_cvt_pk_bf16_f32 v202, v140, v141
    v_mfma_f32_16x16x32_bf16 a[56:59], a[248:251], v[204:207], a[56:59]
    v_cvt_pk_bf16_f32 v203, v142, v143
    v_xor_b32 v1, s26, v1
    v_smfmac_f32_16x16x64_bf16 v[4:7], v[252:255], v[186:193], v14
    v_exp_f32 v144, v144
    v_mfma_f32_16x16x32_bf16 a[60:63], a[252:255], v[204:207], a[60:63]
    buffer_load_dwordx4 v12, s[12:15], s22 offen offset:2176 nt lds
    v_mfma_f32_16x16x32_bf16 a[40:43], a[248:251], v[198:201], a[40:43]
    s_add_u32 s22, s22, 0x4000
    v_exp_f32 v145, v145
    v_mfma_f32_16x16x32_bf16 a[44:47], a[252:255], v[198:201], a[44:47]
    s_add_u32 s57, s57, 0x4000
    v_add_f32 v8, v144, v8
    v_cvt_pk_bf16_f32 v208, v144, v145
    v_mfma_f32_16x16x32_bf16 a[24:27], a[248:251], v[192:195], a[24:27]
    s_xor_b32 s24, s24, s26
    v_exp_f32 v146, v146
    v_mfma_f32_16x16x32_bf16 a[28:31], a[252:255], v[192:195], a[28:31]
    s_bitset0_b32 s22, 19
    v_add_f32 v8, v145, v8
    v_add_f32 v8, v146, v8
    v_mfma_f32_16x16x32_bf16 a[8:11], a[248:251], v[186:189], a[8:11]
    s_andn2_b32 s14, 0x80000, s57
    v_exp_f32 v147, v147
    v_mfma_f32_16x16x32_bf16 a[12:15], a[252:255], v[186:189], a[12:15]
    s_waitcnt lgkmcnt(3)
    v_cvt_pk_bf16_f32 v209, v146, v147
    v_add_f32 v8, v147, v8
    v_mfma_f32_16x16x32_bf16 v[156:159], a[224:227], a[112:115], 4.0
    s_waitcnt lgkmcnt(2)
    v_exp_f32 v148, v148
    v_mfma_f32_16x16x32_bf16 v[156:159], a[228:231], a[116:119], v[156:159]
    s_waitcnt lgkmcnt(1)
    ds_read_b64_tr_b16 a[242:243], v2 offset:1024
    v_add_f32 v4, v128, v4
    v_mfma_f32_16x16x32_bf16 v[156:159], a[232:235], a[120:123], v[156:159]
    s_waitcnt lgkmcnt(1)
    v_exp_f32 v149, v149
    v_mfma_f32_16x16x32_bf16 v[156:159], a[236:239], a[124:127], v[156:159]
    ds_read_b64_tr_b16 a[240:241], v2 offset:5120
    v_cvt_pk_bf16_f32 v214, v148, v149
    v_mfma_f32_16x16x32_bf16 v[160:163], a[236:239], a[140:143], 4.0
    v_exp_f32 v150, v150
    v_mfma_f32_16x16x32_bf16 v[160:163], a[232:235], a[136:139], v[160:163]
    ds_read_b64_tr_b16 a[246:247], v2 offset:1280
    v_cvt_pk_bf16_f32 v184, v128, v129
    v_mfma_f32_16x16x32_bf16 v[160:163], a[228:231], a[132:135], v[160:163]
    v_exp_f32 v151, v151
    v_mfma_f32_16x16x32_bf16 v[160:163], a[224:227], a[128:131], v[160:163]
    v_cvt_pk_bf16_f32 v215, v150, v151
    v_add_f32 v10, v180, v10
    v_mfma_f32_16x16x32_bf16 v[164:167], a[224:227], a[144:147], 4.0
    ds_read_b64_tr_b16 a[244:245], v2 offset:5376
    v_add_f32 v10, v181, v10
    v_mfma_f32_16x16x32_bf16 v[164:167], a[228:231], a[148:151], v[164:167]
    v_exp_f32 v156, v156
    v_mfma_f32_16x16x32_bf16 v[164:167], a[232:235], a[152:155], v[164:167]
    ds_read_b64_tr_b16 a[250:251], v2 offset:1536
    v_add_f32 v4, v156, v4
    v_mfma_f32_16x16x32_bf16 v[164:167], a[236:239], a[156:159], v[164:167]
    v_exp_f32 v157, v157
    v_mfma_f32_16x16x32_bf16 v[168:171], a[236:239], a[172:175], 4.0
    v_add_f32 v4, v157, v4
    v_add_f32 v10, v182, v10
    v_mfma_f32_16x16x32_bf16 v[168:171], a[232:235], a[168:171], v[168:171]
    ds_read_b64_tr_b16 a[248:249], v2 offset:5632
    v_add_f32 v10, v183, v10
    v_mfma_f32_16x16x32_bf16 v[168:171], a[228:231], a[164:167], v[168:171]
    v_exp_f32 v158, v158
    v_mfma_f32_16x16x32_bf16 v[168:171], a[224:227], a[160:163], v[168:171]
    ds_read_b64_tr_b16 a[254:255], v2 offset:1792
    v_add_f32 v4, v158, v4
    v_mfma_f32_16x16x32_bf16 v[172:175], a[224:227], a[176:179], 4.0
    v_exp_f32 v159, v159
    v_mfma_f32_16x16x32_bf16 v[172:175], a[228:231], a[180:183], v[172:175]
    ds_read_b64_tr_b16 a[252:253], v2 offset:5888
    v_add_f32 v4, v159, v4
    v_mfma_f32_16x16x32_bf16 v[172:175], a[232:235], a[184:187], v[172:175]
    v_exp_f32 v160, v160
    v_mfma_f32_16x16x32_bf16 v[172:175], a[236:239], a[188:191], v[172:175]
    v_exp_f32 v161, v161
    v_mfma_f32_16x16x32_bf16 v[176:179], a[236:239], a[204:207], 4.0
    v_xor_b32 v2, s25, v2
    v_add_f32 v5, v160, v5
    v_mfma_f32_16x16x32_bf16 v[176:179], a[232:235], a[200:203], v[176:179]
    v_exp_f32 v162, v162
    v_mfma_f32_16x16x32_bf16 v[176:179], a[228:231], a[196:199], v[176:179]
    v_add_f32 v5, v161, v5
    v_add_f32 v5, v162, v5
    v_mfma_f32_16x16x32_bf16 v[176:179], a[224:227], a[192:195], v[176:179]
    v_exp_f32 v163, v163
    v_smfmac_f32_16x16x64_bf16 v[6:9], v[252:255], v[198:205], v14
    s_waitcnt lgkmcnt(6)
    v_add_f32 v5, v163, v5
    v_mfma_f32_16x16x32_bf16 v[112:115], a[240:243], v[220:223], v[112:115]
    s_waitcnt lgkmcnt(4)
    v_mfma_f32_16x16x32_bf16 v[116:119], a[244:247], v[220:223], v[116:119]
    v_exp_f32 v164, v164
    v_mfma_f32_16x16x32_bf16 v[96:99], a[240:243], v[216:219], v[96:99]
    v_mfma_f32_16x16x32_bf16 v[100:103], a[244:247], v[216:219], v[100:103]
    v_exp_f32 v165, v165
    v_mfma_f32_16x16x32_bf16 v[80:83], a[240:243], v[210:213], v[80:83]
    v_add_f32 v6, v164, v6
    v_add_f32 v6, v165, v6
    v_mfma_f32_16x16x32_bf16 v[84:87], a[244:247], v[210:213], v[84:87]
    s_waitcnt vmcnt(12) lgkmcnt(0)
    v_exp_f32 v166, v166
    v_mfma_f32_16x16x32_bf16 v[64:67], a[240:243], v[204:207], v[64:67]
    s_barrier
    v_mfma_f32_16x16x32_bf16 v[68:71], a[244:247], v[204:207], v[68:71]
    s_mov_b32 m0, s23
    v_mfma_f32_16x16x32_bf16 v[48:51], a[240:243], v[198:201], v[48:51]
    buffer_load_dwordx4 v3, s[8:11], s21 offen offset:0 nt lds
    v_mfma_f32_16x16x32_bf16 v[52:55], a[244:247], v[198:201], v[52:55]
    v_exp_f32 v167, v167
    v_mfma_f32_16x16x32_bf16 v[32:35], a[240:243], v[192:195], v[32:35]
    ds_read_b128 a[224:227], v1 offset:0
    v_add_f32 v6, v166, v6
    v_mfma_f32_16x16x32_bf16 v[36:39], a[244:247], v[192:195], v[36:39]
    v_exp_f32 v168, v168
    v_mfma_f32_16x16x32_bf16 v[16:19], a[240:243], v[186:189], v[16:19]
    buffer_load_dwordx4 v3, s[8:11], s21 offen offset:2048 nt lds
    v_mfma_f32_16x16x32_bf16 v[20:23], a[244:247], v[186:189], v[20:23]
    v_exp_f32 v169, v169
    v_smfmac_f32_16x16x64_bf16 v[8:11], v[252:255], v[210:217], v14
    ds_read_b128 a[228:231], v1 offset:512
    v_add_f32 v6, v167, v6
    v_mfma_f32_16x16x32_bf16 v[24:27], a[248:251], v[186:189], v[24:27]
    v_exp_f32 v170, v170
    v_mfma_f32_16x16x32_bf16 v[28:31], a[252:255], v[186:189], v[28:31]
    s_add_u32 m0, s23, 896
    ds_read_b128 a[232:235], v1 offset:1024
    v_add_f32 v7, v168, v7
    v_mfma_f32_16x16x32_bf16 v[40:43], a[248:251], v[192:195], v[40:43]
    buffer_load_dwordx4 v3, s[8:11], s21 offen offset:128 nt lds
    v_mfma_f32_16x16x32_bf16 v[44:47], a[252:255], v[192:195], v[44:47]
    v_exp_f32 v171, v171
    v_mfma_f32_16x16x32_bf16 v[56:59], a[248:251], v[198:201], v[56:59]
    v_exp_f32 v172, v172
    v_mfma_f32_16x16x32_bf16 v[60:63], a[252:255], v[198:201], v[60:63]
    ds_read_b128 a[236:239], v1 offset:1536
    v_cvt_pk_bf16_f32 v186, v156, v157
    v_mfma_f32_16x16x32_bf16 v[72:75], a[248:251], v[204:207], v[72:75]
    v_exp_f32 v173, v173
    v_mfma_f32_16x16x32_bf16 v[76:79], a[252:255], v[204:207], v[76:79]
    buffer_load_dwordx4 v3, s[8:11], s21 offen offset:2176 nt lds
    v_mfma_f32_16x16x32_bf16 v[88:91], a[248:251], v[210:213], v[88:91]
    v_exp_f32 v174, v174
    v_mfma_f32_16x16x32_bf16 v[92:95], a[252:255], v[210:213], v[92:95]
    v_exp_f32 v175, v175
    v_mfma_f32_16x16x32_bf16 v[104:107], a[248:251], v[216:219], v[104:107]
    v_cvt_pk_bf16_f32 v187, v158, v159
    v_cvt_pk_bf16_f32 v192, v160, v161
    v_mfma_f32_16x16x32_bf16 v[108:111], a[252:255], v[216:219], v[108:111]
    v_exp_f32 v176, v176
    v_mfma_f32_16x16x32_bf16 v[120:123], a[248:251], v[220:223], v[120:123]
    s_sub_u32 s20, s20, 1
    v_cvt_pk_bf16_f32 v193, v162, v163
    v_cvt_pk_bf16_f32 v198, v164, v165
    v_mfma_f32_16x16x32_bf16 v[124:127], a[252:255], v[220:223], v[124:127]
    s_cbranch_scc1 L_tail0
L_B:
    s_waitcnt lgkmcnt(3)
    v_mfma_f32_16x16x32_bf16 v[128:131], a[224:227], a[112:115], 4.0
    s_waitcnt lgkmcnt(2)
    v_exp_f32 v177, v177
    v_mfma_f32_16x16x32_bf16 v[128:131], a[228:231], a[116:119], v[128:131]
    s_waitcnt lgkmcnt(1)
    ds_read_b64_tr_b16 a[240:241], v2 offset:0
    v_cvt_pk_bf16_f32 v199, v166, v167
    v_mfma_f32_16x16x32_bf16 v[128:131], a[232:235], a[120:123], v[128:131]
    s_waitcnt lgkmcnt(1)
    v_exp_f32 v178, v178
    v_mfma_f32_16x16x32_bf16 v[128:131], a[236:239], a[124:127], v[128:131]
    s_add_u32 s21, s21, 0x4000
    v_exp_f32 v179, v179
    v_mfma_f32_16x16x32_bf16 v[132:135], a[236:239], a[140:143], 4.0
    s_add_u32 s56, s56, 0x4000
    ds_read_b64_tr_b16 a[242:243], v2 offset:4096
    v_cvt_pk_bf16_f32 v204, v168, v169
    v_mfma_f32_16x16x32_bf16 v[132:135], a[232:235], a[136:139], v[132:135]
    s_xor_b32 s23, s23, s25
    v_cvt_pk_bf16_f32 v205, v170, v171
    v_cvt_pk_bf16_f32 v210, v172, v173
    v_mfma_f32_16x16x32_bf16 v[132:135], a[228:231], a[132:135], v[132:135]
    s_bitset0_b32 s21, 19
    v_cvt_pk_bf16_f32 v211, v174, v175
    v_cvt_pk_bf16_f32 v216, v176, v177
    v_mfma_f32_16x16x32_bf16 v[132:135], a[224:227], a[128:131], v[132:135]
    s_andn2_b32 s10, 0x80000, s56
    ds_read_b64_tr_b16 a[244:245], v2 offset:256
    v_cvt_pk_bf16_f32 v217, v178, v179
    v_mfma_f32_16x16x32_bf16 v[136:139], a[224:227], a[144:147], 4.0
    v_exp_f32 v128, v128
    v_mfma_f32_16x16x32_bf16 v[136:139], a[228:231], a[148:151], v[136:139]
    v_exp_f32 v129, v129
    v_mfma_f32_16x16x32_bf16 v[136:139], a[232:235], a[152:155], v[136:139]
    ds_read_b64_tr_b16 a[246:247], v2 offset:4352
    v_add_f32 v7, v169, v7
    v_mfma_f32_16x16x32_bf16 v[136:139], a[236:239], a[156:159], v[136:139]
    v_exp_f32 v130, v130
    v_mfma_f32_16x16x32_bf16 v[140:143], a[236:239], a[172:175], 4.0
    ds_read_b64_tr_b16 a[248:249], v2 offset:512
    v_add_f32 v7, v170, v7
    v_mfma_f32_16x16x32_bf16 v[140:143], a[232:235], a[168:171], v[140:143]
    v_exp_f32 v131, v131
    v_mfma_f32_16x16x32_bf16 v[140:143], a[228:231], a[164:167], v[140:143]
    v_exp_f32 v132, v132
    v_mfma_f32_16x16x32_bf16 v[140:143], a[224:227], a[160:163], v[140:143]
    ds_read_b64_tr_b16 a[250:251], v2 offset:4608
    v_add_f32 v7, v171, v7
    v_mfma_f32_16x16x32_bf16 v[144:147], a[224:227], a[176:179], 4.0
    v_exp_f32 v133, v133
    v_mfma_f32_16x16x32_bf16 v[144:147], a[228:231], a[180:183], v[144:147]
    v_exp_f32 v134, v134
    v_mfma_f32_16x16x32_bf16 v[144:147], a[232:235], a[184:187], v[144:147]
    ds_read_b64_tr_b16 a[252:253], v2 offset:768
    v_add_f32 v8, v172, v8
    v_mfma_f32_16x16x32_bf16 v[144:147], a[236:239], a[188:191], v[144:147]
    v_exp_f32 v135, v135
    v_mfma_f32_16x16x32_bf16 v[148:151], a[236:239], a[204:207], 4.0
    v_add_f32 v8, v173, v8
    v_add_f32 v8, v174, v8
    v_mfma_f32_16x16x32_bf16 v[148:151], a[232:235], a[200:203], v[148:151]
    ds_read_b64_tr_b16 a[254:255], v2 offset:4864
    v_add_f32 v8, v175, v8
    v_mfma_f32_16x16x32_bf16 v[148:151], a[228:231], a[196:199], v[148:151]
    v_exp_f32 v136, v136
    v_mfma_f32_16x16x32_bf16 v[148:151], a[224:227], a[192:195], v[148:151]
    v_exp_f32 v137, v137
    v_mfma_f32_16x16x32_bf16 v[152:155], a[224:227], a[208:211], 4.0
    v_add_f32 v9, v176, v9
    v_add_f32 v9, v177, v9
    v_mfma_f32_16x16x32_bf16 v[152:155], a[228:231], a[212:215], v[152:155]
    v_exp_f32 v138, v138
    v_mfma_f32_16x16x32_bf16 v[152:155], a[232:235], a[216:219], v[152:155]
    s_mov_b32 m0, s24
    v_add_f32 v9, v178, v9
    v_add_f32 v9, v179, v9
    v_mfma_f32_16x16x32_bf16 v[152:155], a[236:239], a[220:223], v[152:155]
    s_waitcnt lgkmcnt(6)
    v_exp_f32 v139, v139
    v_mfma_f32_16x16x32_bf16 a[0:3], a[240:243], v[184:187], a[0:3]
    s_waitcnt lgkmcnt(4)
    v_cvt_pk_bf16_f32 v188, v128, v129
    v_cvt_pk_bf16_f32 v189, v130, v131
    v_mfma_f32_16x16x32_bf16 a[4:7], a[244:247], v[184:187], a[4:7]
    buffer_load_dwordx4 v12, s[12:15], s22 offen offset:0 nt lds
    v_mfma_f32_16x16x32_bf16 a[16:19], a[240:243], v[190:193], a[16:19]
    v_exp_f32 v140, v140
    v_mfma_f32_16x16x32_bf16 a[20:23], a[244:247], v[190:193], a[20:23]
    ds_read_b128 a[224:227], v1 offset:4096
    v_add_f32 v5, v132, v5
    v_mfma_f32_16x16x32_bf16 a[32:35], a[240:243], v[196:199], a[32:35]
    v_exp_f32 v141, v141
    v_mfma_f32_16x16x32_bf16 a[36:39], a[244:247], v[196:199], a[36:39]
    v_exp_f32 v142, v142
    v_mfma_f32_16x16x32_bf16 a[48:51], a[240:243], v[202:205], a[48:51]
    ds_read_b128 a[228:231], v1 offset:4608
    v_cvt_pk_bf16_f32 v194, v132, v133
    v_mfma_f32_16x16x32_bf16 a[52:55], a[244:247], v[202:205], a[52:55]
    buffer_load_dwordx4 v12, s[12:15], s22 offen offset:2048 nt lds
    v_mfma_f32_16x16x32_bf16 a[64:67], a[240:243], v[208:211], a[64:67]
    v_exp_f32 v143, v143
    v_mfma_f32_16x16x32_bf16 a[68:71], a[244:247], v[208:211], a[68:71]
    v_exp_f32 v144, v144
    v_mfma_f32_16x16x32_bf16 a[80:83], a[240:243], v[214:217], a[80:83]
    s_add_u32 m0, s24, s47
    v_add_f32 v5, v133, v5
    v_add_f32 v5, v134, v5
    v_mfma_f32_16x16x32_bf16 a[84:87], a[244:247], v[214:217], a[84:87]
    s_waitcnt lgkmcnt(4)
    ds_read_b128 a[232:235], v1 offset:5120
    v_cvt_pk_bf16_f32 v195, v134, v135
    v_mfma_f32_16x16x32_bf16 a[88:91], a[248:251], v[214:217], a[88:91]
    s_waitcnt lgkmcnt(3)
    v_exp_f32 v145, v145
    v_mfma_f32_16x16x32_bf16 a[92:95], a[252:255], v[214:217], a[92:95]
    buffer_load_dwordx4 v12, s[12:15], s22 offen offset:128 nt lds
    v_mfma_f32_16x16x32_bf16 a[72:75], a[248:251], v[208:211], a[72:75]
    v_exp_f32 v146, v146
    v_mfma_f32_16x16x32_bf16 a[76:79], a[252:255], v[208:211], a[76:79]
    ds_read_b128 a[236:239], v1 offset:5632
    v_add_f32 v5, v135, v5
    v_mfma_f32_16x16x32_bf16 a[56:59], a[248:251], v[202:205], a[56:59]
    v_exp_f32 v147, v147
    v_mfma_f32_16x16x32_bf16 a[60:63], a[252:255], v[202:205], a[60:63]
    v_exp_f32 v148, v148
    v_mfma_f32_16x16x32_bf16 a[40:43], a[248:251], v[196:199], a[40:43]
    v_exp_f32 v149, v149
    v_mfma_f32_16x16x32_bf16 a[44:47], a[252:255], v[196:199], a[44:47]
    buffer_load_dwordx4 v12, s[12:15], s22 offen offset:2176 nt lds
    v_mfma_f32_16x16x32_bf16 a[24:27], a[248:251], v[190:193], a[24:27]
    s_add_u32 s22, s22, 0x4000
    v_exp_f32 v150, v150
    v_mfma_f32_16x16x32_bf16 a[28:31], a[252:255], v[190:193], a[28:31]
    s_add_u32 s57, s57, 0x4000
    v_xor_b32 v1, s25, v1
    v_cvt_pk_bf16_f32 v200, v136, v137
    v_mfma_f32_16x16x32_bf16 a[8:11], a[248:251], v[184:187], a[8:11]
    s_xor_b32 s24, s24, s25
    v_exp_f32 v151, v151
    v_mfma_f32_16x16x32_bf16 a[12:15], a[252:255], v[184:187], a[12:15]
    s_waitcnt lgkmcnt(3)
    v_cvt_pk_bf16_f32 v201, v138, v139
    v_add_f32 v7, v140, v7
    v_mfma_f32_16x16x32_bf16 v[156:159], a[224:227], a[112:115], 4.0
    s_waitcnt lgkmcnt(2)
    v_exp_f32 v152, v152
    v_mfma_f32_16x16x32_bf16 v[156:159], a[228:231], a[116:119], v[156:159]
    s_waitcnt lgkmcnt(1)
    ds_read_b64_tr_b16 a[240:241], v2 offset:1024
    v_cvt_pk_bf16_f32 v206, v140, v141
    v_mfma_f32_16x16x32_bf16 v[156:159], a[232:235], a[120:123], v[156:159]
    s_waitcnt lgkmcnt(1)
    v_exp_f32 v153, v153
    v_mfma_f32_16x16x32_bf16 v[156:159], a[236:239], a[124:127], v[156:159]
    s_bitset0_b32 s22, 19
    v_add_f32 v7, v141, v7
    v_add_f32 v7, v142, v7
    v_mfma_f32_16x16x32_bf16 v[160:163], a[236:239], a[140:143], 4.0
    s_andn2_b32 s14, 0x80000, s57
    ds_read_b64_tr_b16 a[242:243], v2 offset:5120
    v_cvt_pk_bf16_f32 v207, v142, v143
    v_mfma_f32_16x16x32_bf16 v[160:163], a[232:235], a[136:139], v[160:163]
    v_exp_f32 v154, v154
    v_mfma_f32_16x16x32_bf16 v[160:163], a[228:231], a[132:135], v[160:163]
    ds_read_b64_tr_b16 a[244:245], v2 offset:1280
    v_add_f32 v7, v143, v7
    v_mfma_f32_16x16x32_bf16 v[160:163], a[224:227], a[128:131], v[160:163]
    v_exp_f32 v155, v155
    v_mfma_f32_16x16x32_bf16 v[164:167], a[224:227], a[144:147], 4.0
    v_exp_f32 v156, v156
    v_mfma_f32_16x16x32_bf16 v[164:167], a[228:231], a[148:151], v[164:167]
    ds_read_b64_tr_b16 a[246:247], v2 offset:5376
    v_cvt_pk_bf16_f32 v212, v144, v145
    v_mfma_f32_16x16x32_bf16 v[164:167], a[232:235], a[152:155], v[164:167]
    v_exp_f32 v157, v157
    v_mfma_f32_16x16x32_bf16 v[164:167], a[236:239], a[156:159], v[164:167]
    v_cvt_pk_bf16_f32 v213, v146, v147
    v_add_f32 v9, v148, v9
    v_mfma_f32_16x16x32_bf16 v[168:171], a[236:239], a[172:175], 4.0
    ds_read_b64_tr_b16 a[248:249], v2 offset:1536
    v_cvt_pk_bf16_f32 v218, v148, v149
    v_mfma_f32_16x16x32_bf16 v[168:171], a[232:235], a[168:171], v[168:171]
    v_exp_f32 v158, v158
    v_mfma_f32_16x16x32_bf16 v[168:171], a[228:231], a[164:167], v[168:171]
    v_exp_f32 v159, v159
    v_mfma_f32_16x16x32_bf16 v[168:171], a[224:227], a[160:163], v[168:171]
    ds_read_b64_tr_b16 a[250:251], v2 offset:5632
    v_add_f32 v9, v149, v9
    v_mfma_f32_16x16x32_bf16 v[172:175], a[224:227], a[176:179], 4.0
    v_exp_f32 v160, v160
    v_mfma_f32_16x16x32_bf16 v[172:175], a[228:231], a[180:183], v[172:175]
    ds_read_b64_tr_b16 a[252:253], v2 offset:1792
    v_add_f32 v9, v150, v9
    v_mfma_f32_16x16x32_bf16 v[172:175], a[232:235], a[184:187], v[172:175]
    v_exp_f32 v161, v161
    v_mfma_f32_16x16x32_bf16 v[172:175], a[236:239], a[188:191], v[172:175]
    v_cvt_pk_bf16_f32 v219, v150, v151
    v_add_f32 v9, v151, v9
    v_mfma_f32_16x16x32_bf16 v[176:179], a[236:239], a[204:207], 4.0
    ds_read_b64_tr_b16 a[254:255], v2 offset:5888
    v_cvt_pk_bf16_f32 v222, v152, v153
    v_mfma_f32_16x16x32_bf16 v[176:179], a[232:235], a[200:203], v[176:179]
    v_exp_f32 v162, v162
    v_mfma_f32_16x16x32_bf16 v[176:179], a[228:231], a[196:199], v[176:179]
    v_exp_f32 v163, v163
    v_mfma_f32_16x16x32_bf16 v[176:179], a[224:227], a[192:195], v[176:179]
    v_xor_b32 v2, s26, v2
    v_cvt_pk_bf16_f32 v223, v154, v155
    v_mfma_f32_16x16x32_bf16 v[180:183], a[224:227], a[208:211], 4.0
    v_exp_f32 v164, v164
    v_mfma_f32_16x16x32_bf16 v[180:183], a[228:231], a[212:215], v[180:183]
    v_add_f32 v10, v152, v10
    v_add_f32 v10, v153, v10
    v_mfma_f32_16x16x32_bf16 v[180:183], a[232:235], a[216:219], v[180:183]
    v_exp_f32 v165, v165
    v_mfma_f32_16x16x32_bf16 v[180:183], a[236:239], a[220:223], v[180:183]
    s_waitcnt lgkmcnt(6)
    v_exp_f32 v166, v166
    v_mfma_f32_16x16x32_bf16 v[96:99], a[240:243], v[214:217], v[96:99]
    s_waitcnt lgkmcnt(4)
    v_add_f32 v10, v154, v10
    v_add_f32 v10, v155, v10
    v_mfma_f32_16x16x32_bf16 v[100:103], a[244:247], v[214:217], v[100:103]
    v_exp_f32 v167, v167
    v_mfma_f32_16x16x32_bf16 v[80:83], a[240:243], v[208:211], v[80:83]
    s_waitcnt vmcnt(12) lgkmcnt(0)
    v_mfma_f32_16x16x32_bf16 v[84:87], a[244:247], v[208:211], v[84:87]
    s_barrier
    v_mfma_f32_16x16x32_bf16 v[64:67], a[240:243], v[202:205], v[64:67]
    v_mfma_f32_16x16x32_bf16 v[68:71], a[244:247], v[202:205], v[68:71]
    v_exp_f32 v168, v168
    v_mfma_f32_16x16x32_bf16 v[48:51], a[240:243], v[196:199], v[48:51]
    s_mov_b32 m0, s23
    ds_read_b128 a[224:227], v1 offset:0
    v_mfma_f32_16x16x32_bf16 v[52:55], a[244:247], v[196:199], v[52:55]
    buffer_load_dwordx4 v3, s[8:11], s21 offen offset:0 nt lds
    v_mfma_f32_16x16x32_bf16 v[32:35], a[240:243], v[190:193], v[32:35]
    v_exp_f32 v169, v169
    v_mfma_f32_16x16x32_bf16 v[36:39], a[244:247], v[190:193], v[36:39]
    ds_read_b128 a[228:231], v1 offset:512
    v_mfma_f32_16x16x32_bf16 v[16:19], a[240:243], v[184:187], v[16:19]
    v_exp_f32 v170, v170
    v_mfma_f32_16x16x32_bf16 v[20:23], a[244:247], v[184:187], v[20:23]
    ds_read_b128 a[232:235], v1 offset:1024
    v_mfma_f32_16x16x32_bf16 v[24:27], a[248:251], v[184:187], v[24:27]
    v_exp_f32 v171, v171
    v_mfma_f32_16x16x32_bf16 v[28:31], a[252:255], v[184:187], v[28:31]
    buffer_load_dwordx4 v3, s[8:11], s21 offen offset:2048 nt lds
    v_mfma_f32_16x16x32_bf16 v[40:43], a[248:251], v[190:193], v[40:43]
    ds_read_b128 a[236:239], v1 offset:1536
    v_cvt_pk_bf16_f32 v186, v156, v157
    v_mfma_f32_16x16x32_bf16 v[44:47], a[252:255], v[190:193], v[44:47]
    s_add_u32 m0, s23, 896
    v_exp_f32 v172, v172
    v_mfma_f32_16x16x32_bf16 v[56:59], a[248:251], v[196:199], v[56:59]
    buffer_load_dwordx4 v3, s[8:11], s21 offen offset:128 nt lds
    v_mfma_f32_16x16x32_bf16 v[60:63], a[252:255], v[196:199], v[60:63]
    v_exp_f32 v173, v173
    v_mfma_f32_16x16x32_bf16 v[72:75], a[248:251], v[202:205], v[72:75]
    v_exp_f32 v174, v174
    v_mfma_f32_16x16x32_bf16 v[76:79], a[252:255], v[202:205], v[76:79]
    v_exp_f32 v175, v175
    v_mfma_f32_16x16x32_bf16 v[88:91], a[248:251], v[208:211], v[88:91]
    v_exp_f32 v176, v176
    v_mfma_f32_16x16x32_bf16 v[92:95], a[252:255], v[208:211], v[92:95]
    buffer_load_dwordx4 v3, s[8:11], s21 offen offset:2176 nt lds
    v_mfma_f32_16x16x32_bf16 v[104:107], a[248:251], v[214:217], v[104:107]
    s_sub_u32 s20, s20, 1
    v_exp_f32 v177, v177
    v_mfma_f32_16x16x32_bf16 v[108:111], a[252:255], v[214:217], v[108:111]
    s_cbranch_scc0 L_A
L_tail1:
    s_mov_b32 s53, 0x2b800000
    ds_read_b64_tr_b16 a[242:243], v2 offset:0
    ds_read_b64_tr_b16 a[246:247], v2 offset:256
    ds_read_b64_tr_b16 a[244:245], v2 offset:4352
    ds_read_b64_tr_b16 a[250:251], v2 offset:512
    ds_read_b64_tr_b16 a[248:249], v2 offset:4608
    ds_read_b64_tr_b16 a[252:253], v2 offset:4864
    ds_read_b64_tr_b16 a[254:255], v2 offset:768
    ds_read_b64_tr_b16 a[240:241], v2 offset:4096
    v_bitop3_b32 v245, s99, v100, v104 bitop3:0x7e
    v_bitop3_b32 v241, s99, v36, v40 bitop3:0x7e
    v_bitop3_b32 v243, s99, v68, v72 bitop3:0x7e
    v_bitop3_b32 v241, v44, v33, v241 bitop3:0xbe
    v_xor_b32_dpp v252, v253, v252 quad_perm:[0,1,2,3] row_mask:0xc bank_mask:0xf
    v_bitop3_b32 v241, v37, v41, v241 bitop3:0xbe
    v_bitop3_b32 v243, v76, v65, v243 bitop3:0xbe
    v_bitop3_b32 v246, s99, v116, v120 bitop3:0x7e
    v_bitop3_b32 v246, v124, v113, v246 bitop3:0xbe
    v_bitop3_b32 v246, v117, v121, v246 bitop3:0xbe
    v_bitop3_b32 v243, v69, v73, v243 bitop3:0xbe
    v_bitop3_b32 v243, v77, v66, v243 bitop3:0xbe
    v_bitop3_b32 v243, v70, v74, v243 bitop3:0xbe
    v_bitop3_b32 v240, s99, v20, v24 bitop3:0x7e
    v_bitop3_b32 v240, v28, v17, v240 bitop3:0xbe
    v_bitop3_b32 v240, v21, v25, v240 bitop3:0xbe
    v_bitop3_b32 v240, v29, v18, v240 bitop3:0xbe
    v_bitop3_b32 v240, v22, v26, v240 bitop3:0xbe
    v_bitop3_b32 v242, s99, v52, v56 bitop3:0x7e
    v_bitop3_b32 v242, v60, v49, v242 bitop3:0xbe
    v_bitop3_b32 v242, v53, v57, v242 bitop3:0xbe
    v_bitop3_b32 v246, v125, v114, v246 bitop3:0xbe
    v_bitop3_b32 v246, v118, v122, v246 bitop3:0xbe
    v_bitop3_b32 v246, v126, v115, v246 bitop3:0xbe
    v_bitop3_b32 v242, v61, v50, v242 bitop3:0xbe
    v_xor_b32_dpp v254, v255, v254 quad_perm:[0,1,2,3] row_mask:0xc bank_mask:0xf
    v_bitop3_b32 v241, v45, v34, v241 bitop3:0xbe
    v_bitop3_b32 v241, v38, v42, v241 bitop3:0xbe
    v_bitop3_b32 v242, v54, v58, v242 bitop3:0xbe
    v_min3_u32 v240, v240, v241, v242
    v_bitop3_b32 v244, s99, v84, v88 bitop3:0x7e
    v_bitop3_b32 v244, v92, v81, v244 bitop3:0xbe
    v_bitop3_b32 v244, v85, v89, v244 bitop3:0xbe
    v_bitop3_b32 v244, v93, v82, v244 bitop3:0xbe
    v_bitop3_b32 v244, v86, v90, v244 bitop3:0xbe
    v_bitop3_b32 v245, v108, v97, v245 bitop3:0xbe
    v_bitop3_b32 v245, v101, v105, v245 bitop3:0xbe
    v_bitop3_b32 v245, v109, v98, v245 bitop3:0xbe
    v_bitop3_b32 v245, v102, v106, v245 bitop3:0xbe
    v_min3_u32 v243, v243, v244, v245
    v_min3_u32 v240, v240, v243, v246
    v_cmp_gt_u32 s[96:97], s98, v240
    v_lshlrev_b32 v13, 4, v0
    v_add_u32 v224, s58, v13
    v_add_u32 v225, 65536, v224
    v_add_u32 v226, 126976, v224
    s_waitcnt vmcnt(0)
    s_waitcnt lgkmcnt(10)
    ds_read_b64_tr_b16 a[228:229], v2 offset:5376
    ds_read_b64_tr_b16 a[226:227], v2 offset:1024
    ds_read_b64_tr_b16 a[230:231], v2 offset:1280
    ds_read_b64_tr_b16 a[224:225], v2 offset:5120
    s_waitcnt lgkmcnt(12)
    ds_read_b64_tr_b16 a[238:239], v2 offset:1792
    ds_read_b64_tr_b16 a[234:235], v2 offset:1536
    ds_read_b64_tr_b16 a[236:237], v2 offset:5888
    ds_read_b64_tr_b16 a[232:233], v2 offset:5632
    v_cvt_pk_bf16_f32 v187, v158, v159
    s_waitcnt lgkmcnt(9)
    s_nop 0
    v_mfma_f32_16x16x32_bf16 a[12:15], a[252:255], v[186:189], a[12:15]
    s_waitcnt lgkmcnt(8)
    v_cvt_pk_bf16_f32 v192, v160, v161
    v_xor_b32 v228, 0x2000, v225
    v_mfma_f32_16x16x32_bf16 a[0:3], a[240:243], v[186:189], a[0:3]
    v_and_b32 v13, 15, v0
    v_xor_b32 v229, 0x2000, v226
    v_mfma_f32_16x16x32_bf16 a[8:11], a[248:251], v[186:189], a[8:11]
    s_lshl_b32 s50, s29, 7
    ds_write_b128 v224, a[12:15] offset:3072
    v_mfma_f32_16x16x32_bf16 a[4:7], a[244:247], v[186:189], a[4:7]
    s_waitcnt lgkmcnt(2)
    s_nop 0
    ds_write_b128 v224, a[0:3] offset:0
    v_mfma_f32_16x16x32_bf16 v[28:31], a[236:239], v[186:189], v[28:31]
    s_mov_b32 s52, 0x53800000
    s_movk_i32 s49, 0xff40
    ds_write_b128 v224, a[8:11] offset:2048
    v_mfma_f32_16x16x32_bf16 v[16:19], a[224:227], v[186:189], v[16:19]
    s_mov_b32 vcc_lo, 0x55555555
    v_xor_b32 v227, 0x2000, v224
    v_mfma_f32_16x16x32_bf16 v[20:23], a[228:231], v[186:189], v[20:23]
    s_waitcnt lgkmcnt(3)
    ds_write_b128 v224, a[4:7] offset:1024
    v_mfma_f32_16x16x32_bf16 v[24:27], a[232:235], v[186:189], v[24:27]
    s_mov_b32 vcc_hi, 0x55555555
    v_lshlrev_b32 v233, 8, v13
    v_bfe_u32 v13, v0, 4, 1
    v_lshl_add_u32 v233, v13, 5, v233
    v_lshrrev_b32 v13, 5, v0
    v_lshl_add_u32 v233, v13, 4, v233
    v_and_b32 v13, 1, v0
    v_add_u32 v231, s50, v233
    v_mad_i32_i24 v230, v13, s49, v231
    s_mov_b32 s51, 0xc000
    v_cvt_pk_bf16_f32 v193, v162, v163
    v_cvt_pk_bf16_f32 v199, v166, v167
    v_cvt_pk_bf16_f32 v198, v164, v165
    v_smfmac_f32_16x16x64_bf16 v[4:7], v[252:255], v[186:193], v14
    v_cvt_pk_bf16_f32 v204, v168, v169
    v_cvt_pk_bf16_f32 v205, v170, v171
    v_mfma_f32_16x16x32_bf16 a[20:23], a[244:247], v[192:195], a[20:23]
    v_cvt_pk_bf16_f32 v210, v172, v173
    v_cvt_pk_bf16_f32 v211, v174, v175
    v_mfma_f32_16x16x32_bf16 a[24:27], a[248:251], v[192:195], a[24:27]
    s_nop 1
    v_permlane32_swap_b32 v4, v5
    v_add_f32 v4, v4, v5
    v_smfmac_f32_16x16x64_bf16 v[6:9], v[252:255], v[198:205], v14
    v_exp_f32 v178, v178
    v_mfma_f32_16x16x32_bf16 a[16:19], a[240:243], v[192:195], a[16:19]
    ds_write_b128 v224, a[20:23] offset:17408
    s_nop 4
    v_permlane32_swap_b32 v6, v7
    v_add_f32 v6, v6, v7
    v_mfma_f32_16x16x32_bf16 a[28:31], a[252:255], v[192:195], a[28:31]
    s_nop 0
    v_permlane16_swap_b32 v4, v6
    v_add_f32 v4, v4, v6
    ds_write_b32 v226, v4 offset:6144
    v_mfma_f32_16x16x32_bf16 a[44:47], a[252:255], v[198:201], a[44:47]
    ds_write_b128 v224, a[24:27] offset:18432
    v_mfma_f32_16x16x32_bf16 a[36:39], a[244:247], v[198:201], a[36:39]
    s_nop 0
    ds_write_b128 v224, a[28:31] offset:19456
    v_mfma_f32_16x16x32_bf16 a[32:35], a[240:243], v[198:201], a[32:35]
    v_cvt_pk_bf16_f32 v216, v176, v177
    v_exp_f32 v179, v179
    v_mfma_f32_16x16x32_bf16 a[40:43], a[248:251], v[198:201], a[40:43]
    ds_write_b128 v224, a[16:19] offset:16384
    s_waitcnt lgkmcnt(3)
    s_barrier
    v_mfma_f32_16x16x32_bf16 a[60:63], a[252:255], v[204:207], a[60:63]
    ds_read_b32 v232, v229 offset:6144
    ds_read_b128 v[136:139], v227 offset:2048
    v_mfma_f32_16x16x32_bf16 a[56:59], a[248:251], v[204:207], a[56:59]
    ds_read_b128 v[128:131], v227 offset:0
    v_mfma_f32_16x16x32_bf16 a[52:55], a[244:247], v[204:207], a[52:55]
    ds_read_b128 v[140:143], v227 offset:3072
    v_mfma_f32_16x16x32_bf16 a[48:51], a[240:243], v[204:207], a[48:51]
    ds_read_b128 v[132:135], v227 offset:1024
    v_mfma_f32_16x16x32_bf16 a[64:67], a[240:243], v[210:213], a[64:67]
    ds_write_b128 v224, a[36:39] offset:33792
    v_mfma_f32_16x16x32_bf16 a[72:75], a[248:251], v[210:213], a[72:75]
    v_cvt_pk_bf16_f32 v217, v178, v179
    v_exp_f32 v180, v180
    ds_write_b128 v224, a[40:43] offset:34816
    s_waitcnt lgkmcnt(6)
    v_add_f32 v232, v232, v4
    v_rcp_f32 v4, v232
    s_waitcnt lgkmcnt(5)
    v_pk_add_f32 v[24:25], v[24:25], v[136:137]
    v_mov_b32 v6, v4
    s_waitcnt lgkmcnt(4)
    v_pk_add_f32 v[18:19], v[18:19], v[130:131]
    v_pk_add_f32 v[26:27], v[26:27], v[138:139]
    v_permlane16_swap_b32 v4, v6
    v_mov_b32 v5, v4
    v_mov_b32 v7, v6
    s_waitcnt lgkmcnt(3)
    v_pk_add_f32 v[30:31], v[30:31], v[142:143]
    v_permlane32_swap_b32 v4, v5
    v_permlane32_swap_b32 v6, v7
    s_waitcnt lgkmcnt(2)
    v_pk_add_f32 v[22:23], v[22:23], v[134:135]
    v_pk_mul_f32 v[18:19], v[18:19], v[4:5] op_sel_hi:[1,0]
    v_pk_add_f32 v[20:21], v[20:21], v[132:133]
    v_pk_mul_f32 v[20:21], v[20:21], v[4:5] op_sel_hi:[1,0]
    v_pk_mul_f32 v[26:27], v[26:27], v[4:5] op_sel_hi:[1,0]
    v_pk_mul_f32 v[22:23], v[22:23], v[4:5] op_sel_hi:[1,0]
    v_pk_mul_f32 v[24:25], v[24:25], v[4:5] op_sel_hi:[1,0]
    v_cvt_pk_bf16_f32 v24, v24, v25
    v_cvt_pk_bf16_f32 v25, v26, v27
    v_pk_add_f32 v[16:17], v[16:17], v[128:129]
    v_pk_mul_f32 v[16:17], v[16:17], v[4:5] op_sel_hi:[1,0]
    v_cvt_pk_bf16_f32 v16, v16, v17
    v_cvt_pk_bf16_f32 v17, v18, v19
    v_cvt_pk_bf16_f32 v18, v20, v21
    v_cvt_pk_bf16_f32 v19, v22, v23
    v_pk_add_f32 v[28:29], v[28:29], v[140:141]
    v_pk_mul_f32 v[28:29], v[28:29], v[4:5] op_sel_hi:[1,0]
    v_cvt_pk_bf16_f32 v26, v28, v29
    v_permlane16_swap_b32 v17, v19
    v_pk_mul_f32 v[30:31], v[30:31], v[4:5] op_sel_hi:[1,0]
    v_cvt_pk_bf16_f32 v27, v30, v31
    v_permlane16_swap_b32 v24, v26
    v_permlane16_swap_b32 v16, v18
    v_permlane16_swap_b32 v25, v27
    ds_write_b128 v224, a[44:47] offset:35840
    v_cndmask_b32_dpp v20, v24, v16, vcc quad_perm:[1,0,3,2] row_mask:0xf bank_mask:0xf
    v_cndmask_b32_dpp v21, v25, v17, vcc quad_perm:[1,0,3,2] row_mask:0xf bank_mask:0xf
    v_cndmask_b32_dpp v23, v27, v19, vcc quad_perm:[1,0,3,2] row_mask:0xf bank_mask:0xf
    v_cndmask_b32_dpp v22, v26, v18, vcc quad_perm:[1,0,3,2] row_mask:0xf bank_mask:0xf
    s_not_b64 vcc, vcc
    v_cndmask_b32_dpp v31, v19, v27, vcc quad_perm:[1,0,3,2] row_mask:0xf bank_mask:0xf
    v_cndmask_b32_dpp v28, v16, v24, vcc quad_perm:[1,0,3,2] row_mask:0xf bank_mask:0xf
    v_cndmask_b32_dpp v30, v18, v26, vcc quad_perm:[1,0,3,2] row_mask:0xf bank_mask:0xf
    buffer_store_dwordx4 v[20:23], v230, s[16:19], s40 offen offset:0 sc0 sc1 nt
    v_cndmask_b32_dpp v29, v17, v25, vcc quad_perm:[1,0,3,2] row_mask:0xf bank_mask:0xf
    buffer_store_dwordx4 v[28:31], v230, s[16:19], s40 offen offset:256 sc0 sc1 nt
    ds_write_b128 v224, a[32:35] offset:32768
    v_add_f32 v10, v180, v10
    v_mfma_f32_16x16x32_bf16 a[68:71], a[244:247], v[210:213], a[68:71]
    ds_write_b128 v224, a[60:63] offset:52224
    v_mfma_f32_16x16x32_bf16 a[76:79], a[252:255], v[210:213], a[76:79]
    v_exp_f32 v181, v181
    ds_write_b128 v224, a[48:51] offset:49152
    v_add_f32 v10, v181, v10
    v_mfma_f32_16x16x32_bf16 v[32:35], a[224:227], v[192:195], v[32:35]
    v_exp_f32 v182, v182
    ds_write_b128 v224, a[56:59] offset:51200
    v_add_f32 v10, v182, v10
    v_mfma_f32_16x16x32_bf16 v[36:39], a[228:231], v[192:195], v[36:39]
    v_exp_f32 v183, v183
    ds_write_b128 v224, a[52:55] offset:50176
    s_waitcnt lgkmcnt(4)
    s_barrier
    v_add_f32 v10, v183, v10
    v_mfma_f32_16x16x32_bf16 v[44:47], a[236:239], v[192:195], v[44:47]
    v_cvt_pk_bf16_f32 v220, v180, v181
    ds_read_b128 v[164:167], v227 offset:33792
    v_smfmac_f32_16x16x64_bf16 v[8:11], v[252:255], v[210:217], v14
    ds_read_b128 v[172:175], v227 offset:35840
    v_mfma_f32_16x16x32_bf16 v[40:43], a[232:235], v[192:195], v[40:43]
    ds_read_b128 v[168:171], v227 offset:34816
    v_mfma_f32_16x16x32_bf16 v[48:51], a[224:227], v[198:201], v[48:51]
    ds_read_b128 v[144:147], v227 offset:16384
    s_nop 2
    v_mov_b32 v11, v10
    ds_read_b128 v[156:159], v227 offset:19456
    s_nop 0
    v_permlane32_swap_b32 v10, v11
    ds_read_b128 v[152:155], v227 offset:18432
    ds_read_b128 v[148:151], v227 offset:17408
    v_add_f32 v10, v10, v11
    ds_read_b128 v[160:163], v227 offset:32768
    v_permlane32_swap_b32 v8, v9
    v_add_f32 v8, v8, v9
    ds_write_b128 v225, a[72:75] offset:2048
    s_nop 0
    v_permlane16_swap_b32 v8, v10
    v_add_f32 v10, v8, v10
    v_min_f32 v15, v232, v10
    v_cmp_nle_f32 s[54:55], s53, v15
    v_add_f32 v11, v232, v10
    v_cndmask_b32 v11, v11, -1, s[96:97]
    v_cndmask_b32 v11, v11, -1, s[54:55]
    ds_write_b64 v226, v[10:11] offset:6152
    ds_write_b128 v225, a[64:67] offset:0
    v_mfma_f32_16x16x32_bf16 v[52:55], a[228:231], v[198:201], v[52:55]
    s_waitcnt lgkmcnt(6)
    v_pk_add_f32 v[46:47], v[46:47], v[158:159]
    v_pk_mul_f32 v[46:47], v[46:47], v[4:5] op_sel:[0,1] op_sel_hi:[1,1]
    v_pk_add_f32 v[32:33], v[32:33], v[144:145]
    ds_write_b128 v225, a[76:79] offset:3072
    v_mfma_f32_16x16x32_bf16 v[56:59], a[232:235], v[198:201], v[56:59]
    s_waitcnt lgkmcnt(4)
    v_pk_add_f32 v[48:49], v[48:49], v[160:161]
    v_pk_add_f32 v[42:43], v[42:43], v[154:155]
    v_mfma_f32_16x16x32_bf16 v[60:63], a[236:239], v[198:201], v[60:63]
    ds_write_b128 v225, a[68:71] offset:1024
    v_pk_mul_f32 v[42:43], v[42:43], v[4:5] op_sel:[0,1] op_sel_hi:[1,1]
    v_pk_add_f32 v[34:35], v[34:35], v[146:147]
    v_pk_mul_f32 v[34:35], v[34:35], v[4:5] op_sel:[0,1] op_sel_hi:[1,1]
    v_pk_add_f32 v[36:37], v[36:37], v[148:149]
    v_pk_mul_f32 v[32:33], v[32:33], v[4:5] op_sel:[0,1] op_sel_hi:[1,1]
    v_cvt_pk_bf16_f32 v32, v32, v33
    v_cvt_pk_bf16_f32 v33, v34, v35
    v_pk_mul_f32 v[36:37], v[36:37], v[4:5] op_sel:[0,1] op_sel_hi:[1,1]
    v_cvt_pk_bf16_f32 v34, v36, v37
    v_pk_add_f32 v[40:41], v[40:41], v[152:153]
    v_pk_mul_f32 v[40:41], v[40:41], v[4:5] op_sel:[0,1] op_sel_hi:[1,1]
    v_pk_add_f32 v[38:39], v[38:39], v[150:151]
    v_cvt_pk_bf16_f32 v40, v40, v41
    v_cvt_pk_bf16_f32 v41, v42, v43
    v_permlane16_swap_b32 v32, v34
    v_pk_mul_f32 v[38:39], v[38:39], v[4:5] op_sel:[0,1] op_sel_hi:[1,1]
    v_cvt_pk_bf16_f32 v35, v38, v39
    v_cvt_pk_bf16_f32 v43, v46, v47
    v_pk_add_f32 v[44:45], v[44:45], v[156:157]
    v_pk_mul_f32 v[44:45], v[44:45], v[4:5] op_sel:[0,1] op_sel_hi:[1,1]
    v_cvt_pk_bf16_f32 v42, v44, v45
    v_permlane16_swap_b32 v33, v35
    v_permlane16_swap_b32 v41, v43
    v_permlane16_swap_b32 v40, v42
    v_pk_add_f32 v[50:51], v[50:51], v[162:163]
    v_cndmask_b32_dpp v47, v35, v43, vcc quad_perm:[1,0,3,2] row_mask:0xf bank_mask:0xf
    v_cndmask_b32_dpp v46, v34, v42, vcc quad_perm:[1,0,3,2] row_mask:0xf bank_mask:0xf
    v_cndmask_b32_dpp v44, v32, v40, vcc quad_perm:[1,0,3,2] row_mask:0xf bank_mask:0xf
    v_cndmask_b32_dpp v45, v33, v41, vcc quad_perm:[1,0,3,2] row_mask:0xf bank_mask:0xf
    buffer_store_dwordx4 v[44:47], v230, s[16:19], s41 offen offset:256 sc0 sc1 nt
    s_not_b64 vcc, vcc
    v_cndmask_b32_dpp v36, v40, v32, vcc quad_perm:[1,0,3,2] row_mask:0xf bank_mask:0xf
    v_cndmask_b32_dpp v38, v42, v34, vcc quad_perm:[1,0,3,2] row_mask:0xf bank_mask:0xf
    v_cndmask_b32_dpp v37, v41, v33, vcc quad_perm:[1,0,3,2] row_mask:0xf bank_mask:0xf
    v_cndmask_b32_dpp v39, v43, v35, vcc quad_perm:[1,0,3,2] row_mask:0xf bank_mask:0xf
    buffer_store_dwordx4 v[36:39], v230, s[16:19], s41 offen offset:0 sc0 sc1 nt
    v_pk_mul_f32 v[50:51], v[50:51], v[6:7] op_sel_hi:[1,0]
    v_pk_add_f32 v[52:53], v[52:53], v[164:165]
    v_pk_mul_f32 v[52:53], v[52:53], v[6:7] op_sel_hi:[1,0]
    v_pk_add_f32 v[58:59], v[58:59], v[170:171]
    v_pk_mul_f32 v[58:59], v[58:59], v[6:7] op_sel_hi:[1,0]
    v_pk_add_f32 v[60:61], v[60:61], v[172:173]
    v_pk_mul_f32 v[60:61], v[60:61], v[6:7] op_sel_hi:[1,0]
    v_pk_add_f32 v[56:57], v[56:57], v[168:169]
    v_pk_mul_f32 v[56:57], v[56:57], v[6:7] op_sel_hi:[1,0]
    v_pk_add_f32 v[62:63], v[62:63], v[174:175]
    v_pk_mul_f32 v[62:63], v[62:63], v[6:7] op_sel_hi:[1,0]
    v_cvt_pk_bf16_f32 v56, v56, v57
    v_cvt_pk_bf16_f32 v57, v58, v59
    v_cvt_pk_bf16_f32 v59, v62, v63
    v_cvt_pk_bf16_f32 v58, v60, v61
    v_pk_mul_f32 v[48:49], v[48:49], v[6:7] op_sel_hi:[1,0]
    v_cvt_pk_bf16_f32 v48, v48, v49
    v_permlane16_swap_b32 v57, v59
    v_cvt_pk_bf16_f32 v49, v50, v51
    v_cvt_pk_bf16_f32 v50, v52, v53
    v_permlane16_swap_b32 v56, v58
    v_pk_add_f32 v[54:55], v[54:55], v[166:167]
    v_permlane16_swap_b32 v48, v50
    v_pk_mul_f32 v[54:55], v[54:55], v[6:7] op_sel_hi:[1,0]
    v_cvt_pk_bf16_f32 v51, v54, v55
    v_cndmask_b32_dpp v54, v58, v50, vcc quad_perm:[1,0,3,2] row_mask:0xf bank_mask:0xf
    v_cndmask_b32_dpp v52, v56, v48, vcc quad_perm:[1,0,3,2] row_mask:0xf bank_mask:0xf
    v_permlane16_swap_b32 v49, v51
    v_cvt_pk_bf16_f32 v221, v182, v183
    v_mfma_f32_16x16x32_bf16 a[92:95], a[252:255], v[216:219], a[92:95]
    v_cndmask_b32_dpp v53, v57, v49, vcc quad_perm:[1,0,3,2] row_mask:0xf bank_mask:0xf
    v_cndmask_b32_dpp v55, v59, v51, vcc quad_perm:[1,0,3,2] row_mask:0xf bank_mask:0xf
    buffer_store_dwordx4 v[52:55], v230, s[16:19], s42 offen offset:0 sc0 sc1 nt
    s_not_b64 vcc, vcc
    v_cndmask_b32_dpp v63, v51, v59, vcc quad_perm:[1,0,3,2] row_mask:0xf bank_mask:0xf
    v_cndmask_b32_dpp v61, v49, v57, vcc quad_perm:[1,0,3,2] row_mask:0xf bank_mask:0xf
    v_cndmask_b32_dpp v62, v50, v58, vcc quad_perm:[1,0,3,2] row_mask:0xf bank_mask:0xf
    v_cndmask_b32_dpp v60, v48, v56, vcc quad_perm:[1,0,3,2] row_mask:0xf bank_mask:0xf
    buffer_store_dwordx4 v[60:63], v230, s[16:19], s42 offen offset:256 sc0 sc1 nt
    v_mfma_f32_16x16x32_bf16 a[96:99], a[240:243], v[220:223], a[96:99]
    ds_write_b128 v225, a[92:95] offset:19456
    v_mfma_f32_16x16x32_bf16 a[104:107], a[248:251], v[220:223], a[104:107]
    s_nop 5
    ds_write_b128 v225, a[96:99] offset:49152
    v_mfma_f32_16x16x32_bf16 a[100:103], a[244:247], v[220:223], a[100:103]
    ds_write_b128 v225, a[104:107] offset:51200
    v_mfma_f32_16x16x32_bf16 a[88:91], a[248:251], v[216:219], a[88:91]
    v_mfma_f32_16x16x32_bf16 a[84:87], a[244:247], v[216:219], a[84:87]
    s_nop 4
    ds_write_b128 v225, a[100:103] offset:50176
    v_mfma_f32_16x16x32_bf16 v[112:115], a[224:227], v[220:223], v[112:115]
    v_mfma_f32_16x16x32_bf16 a[108:111], a[252:255], v[220:223], a[108:111]
    ds_write_b128 v225, a[84:87] offset:17408
    s_waitcnt lgkmcnt(5)
    s_barrier
    v_mfma_f32_16x16x32_bf16 v[116:119], a[228:231], v[220:223], v[116:119]
    ds_read_b64 v[236:237], v226 offset:2056
    ds_read_b64 v[238:239], v229 offset:2056
    ds_read_b64 v[234:235], v229 offset:6152
    ds_read_b128 v[132:135], v227 offset:50176
    v_mfma_f32_16x16x32_bf16 a[80:83], a[240:243], v[216:219], a[80:83]
    ds_read_b128 v[128:131], v227 offset:49152
    v_mfma_f32_16x16x32_bf16 v[64:67], a[224:227], v[204:207], v[64:67]
    ds_read_b128 v[140:143], v227 offset:52224
    v_mfma_f32_16x16x32_bf16 v[72:75], a[232:235], v[204:207], v[72:75]
    ds_read_b128 v[136:139], v227 offset:51200
    v_mfma_f32_16x16x32_bf16 v[68:71], a[228:231], v[204:207], v[68:71]
    ds_read_b128 v[152:155], v228 offset:2048
    v_mfma_f32_16x16x32_bf16 v[76:79], a[236:239], v[204:207], v[76:79]
    ds_read_b128 v[144:147], v228 offset:0
    v_mfma_f32_16x16x32_bf16 v[84:87], a[228:231], v[210:213], v[84:87]
    ds_read_b128 v[148:151], v228 offset:1024
    v_mfma_f32_16x16x32_bf16 v[80:83], a[224:227], v[210:213], v[80:83]
    ds_read_b128 v[156:159], v228 offset:3072
    v_mfma_f32_16x16x32_bf16 v[88:91], a[232:235], v[210:213], v[88:91]
    s_waitcnt lgkmcnt(9)
    v_pk_add_f32 v[236:237], v[236:237], v[238:239]
    s_waitcnt lgkmcnt(8)
    v_pk_add_f32 v[10:11], v[10:11], v[234:235]
    v_add_f32 v11, v11, v237
    ds_write_b128 v225, a[80:83] offset:16384
    v_add_f32_dpp v10, v236, v10 quad_perm:[0,1,2,3] row_mask:0xa bank_mask:0xf
    v_rcp_f32 v8, v10
    ds_write_b128 v225, a[108:111] offset:52224
    v_mov_b32 v10, v8
    v_mfma_f32_16x16x32_bf16 v[92:95], a[236:239], v[210:213], v[92:95]
    s_nop 0
    v_permlane16_swap_b32 v8, v10
    v_mov_b32 v9, v8
    ds_write_b128 v226, v[116:119] offset:5120
    s_nop 0
    v_permlane32_swap_b32 v8, v9
    s_waitcnt lgkmcnt(9)
    v_pk_add_f32 v[66:67], v[66:67], v[130:131]
    v_pk_add_f32 v[64:65], v[64:65], v[128:129]
    s_waitcnt lgkmcnt(8)
    v_pk_add_f32 v[76:77], v[76:77], v[140:141]
    ds_write_b128 v226, v[112:115] offset:4096
    v_pk_mul_f32 v[76:77], v[76:77], v[6:7] op_sel:[0,1] op_sel_hi:[1,1]
    s_waitcnt lgkmcnt(8)
    v_pk_add_f32 v[74:75], v[74:75], v[138:139]
    v_pk_add_f32 v[78:79], v[78:79], v[142:143]
    v_pk_add_f32 v[68:69], v[68:69], v[132:133]
    v_pk_mul_f32 v[68:69], v[68:69], v[6:7] op_sel:[0,1] op_sel_hi:[1,1]
    v_pk_add_f32 v[72:73], v[72:73], v[136:137]
    v_pk_mul_f32 v[72:73], v[72:73], v[6:7] op_sel:[0,1] op_sel_hi:[1,1]
    v_pk_add_f32 v[70:71], v[70:71], v[134:135]
    v_pk_mul_f32 v[70:71], v[70:71], v[6:7] op_sel:[0,1] op_sel_hi:[1,1]
    v_pk_mul_f32 v[74:75], v[74:75], v[6:7] op_sel:[0,1] op_sel_hi:[1,1]
    v_pk_mul_f32 v[66:67], v[66:67], v[6:7] op_sel:[0,1] op_sel_hi:[1,1]
    v_pk_mul_f32 v[64:65], v[64:65], v[6:7] op_sel:[0,1] op_sel_hi:[1,1]
    v_cvt_pk_bf16_f32 v64, v64, v65
    v_cvt_pk_bf16_f32 v65, v66, v67
    v_cvt_pk_bf16_f32 v67, v70, v71
    v_cvt_pk_bf16_f32 v66, v68, v69
    v_cvt_pk_bf16_f32 v72, v72, v73
    v_cvt_pk_bf16_f32 v73, v74, v75
    v_permlane16_swap_b32 v64, v66
    v_cvt_pk_bf16_f32 v74, v76, v77
    v_permlane16_swap_b32 v65, v67
    v_pk_mul_f32 v[78:79], v[78:79], v[6:7] op_sel:[0,1] op_sel_hi:[1,1]
    v_permlane16_swap_b32 v72, v74
    v_cvt_pk_bf16_f32 v75, v78, v79
    s_waitcnt lgkmcnt(6)
    v_pk_add_f32 v[82:83], v[82:83], v[146:147]
    v_cndmask_b32_dpp v76, v64, v72, vcc quad_perm:[1,0,3,2] row_mask:0xf bank_mask:0xf
    v_permlane16_swap_b32 v73, v75
    v_cndmask_b32_dpp v78, v66, v74, vcc quad_perm:[1,0,3,2] row_mask:0xf bank_mask:0xf
    v_pk_add_f32 v[88:89], v[88:89], v[152:153]
    v_cndmask_b32_dpp v77, v65, v73, vcc quad_perm:[1,0,3,2] row_mask:0xf bank_mask:0xf
    v_cndmask_b32_dpp v79, v67, v75, vcc quad_perm:[1,0,3,2] row_mask:0xf bank_mask:0xf
    s_not_b64 vcc, vcc
    v_cndmask_b32_dpp v70, v74, v66, vcc quad_perm:[1,0,3,2] row_mask:0xf bank_mask:0xf
    buffer_store_dwordx4 v[76:79], v230, s[16:19], s43 offen offset:256 sc0 sc1 nt
    v_cndmask_b32_dpp v69, v73, v65, vcc quad_perm:[1,0,3,2] row_mask:0xf bank_mask:0xf
    v_cndmask_b32_dpp v68, v72, v64, vcc quad_perm:[1,0,3,2] row_mask:0xf bank_mask:0xf
    v_cndmask_b32_dpp v71, v75, v67, vcc quad_perm:[1,0,3,2] row_mask:0xf bank_mask:0xf
    v_pk_mul_f32 v[88:89], v[88:89], v[8:9] op_sel_hi:[1,0]
    v_cvt_pk_bf16_f32 v88, v88, v89
    s_waitcnt lgkmcnt(4)
    v_pk_add_f32 v[92:93], v[92:93], v[156:157]
    v_pk_mul_f32 v[92:93], v[92:93], v[8:9] op_sel_hi:[1,0]
    v_pk_add_f32 v[84:85], v[84:85], v[148:149]
    v_pk_mul_f32 v[82:83], v[82:83], v[8:9] op_sel_hi:[1,0]
    v_pk_add_f32 v[94:95], v[94:95], v[158:159]
    v_pk_add_f32 v[86:87], v[86:87], v[150:151]
    v_pk_mul_f32 v[86:87], v[86:87], v[8:9] op_sel_hi:[1,0]
    v_pk_add_f32 v[90:91], v[90:91], v[154:155]
    v_pk_mul_f32 v[90:91], v[90:91], v[8:9] op_sel_hi:[1,0]
    v_cvt_pk_bf16_f32 v89, v90, v91
    v_cvt_pk_bf16_f32 v90, v92, v93
    v_pk_mul_f32 v[94:95], v[94:95], v[8:9] op_sel_hi:[1,0]
    v_cvt_pk_bf16_f32 v91, v94, v95
    v_permlane16_swap_b32 v88, v90
    v_pk_mul_f32 v[84:85], v[84:85], v[8:9] op_sel_hi:[1,0]
    v_permlane16_swap_b32 v89, v91
    v_pk_add_f32 v[80:81], v[80:81], v[144:145]
    v_pk_mul_f32 v[80:81], v[80:81], v[8:9] op_sel_hi:[1,0]
    v_cvt_pk_bf16_f32 v80, v80, v81
    v_cvt_pk_bf16_f32 v81, v82, v83
    v_cvt_pk_bf16_f32 v83, v86, v87
    v_cvt_pk_bf16_f32 v82, v84, v85
    ds_write_b128 v225, a[88:91] offset:18432
    s_nop 0
    v_permlane16_swap_b32 v80, v82
    v_permlane16_swap_b32 v81, v83
    buffer_store_dwordx4 v[68:71], v230, s[16:19], s43 offen offset:0 sc0 sc1 nt
    v_cndmask_b32_dpp v86, v90, v82, vcc quad_perm:[1,0,3,2] row_mask:0xf bank_mask:0xf
    v_cndmask_b32_dpp v85, v89, v81, vcc quad_perm:[1,0,3,2] row_mask:0xf bank_mask:0xf
    v_cndmask_b32_dpp v87, v91, v83, vcc quad_perm:[1,0,3,2] row_mask:0xf bank_mask:0xf
    v_cndmask_b32_dpp v84, v88, v80, vcc quad_perm:[1,0,3,2] row_mask:0xf bank_mask:0xf
    s_not_b64 vcc, vcc
    v_cndmask_b32_dpp v92, v80, v88, vcc quad_perm:[1,0,3,2] row_mask:0xf bank_mask:0xf
    buffer_store_dwordx4 v[84:87], v230, s[16:19], s44 offen offset:0 sc0 sc1 nt
    v_cndmask_b32_dpp v94, v82, v90, vcc quad_perm:[1,0,3,2] row_mask:0xf bank_mask:0xf
    v_cndmask_b32_dpp v95, v83, v91, vcc quad_perm:[1,0,3,2] row_mask:0xf bank_mask:0xf
    v_cndmask_b32_dpp v93, v81, v89, vcc quad_perm:[1,0,3,2] row_mask:0xf bank_mask:0xf
    buffer_store_dwordx4 v[92:95], v230, s[16:19], s44 offen offset:256 sc0 sc1 nt
    v_mfma_f32_16x16x32_bf16 v[108:111], a[236:239], v[216:219], v[108:111]
    s_waitcnt lgkmcnt(0)
    s_barrier
    v_cmp_nge_f32 s[54:55], s52, v11
    s_nop 0
    s_andn2_b64 s[54:55], s[54:55], s[30:31]
    s_cbranch_scc1 L_fallback
    ds_read_b128 v[168:171], v228 offset:18432
    ds_read_b128 v[164:167], v228 offset:17408
    ds_read_b128 v[172:175], v228 offset:19456
    v_mfma_f32_16x16x32_bf16 v[104:107], a[232:235], v[216:219], v[104:107]
    ds_read_b128 v[160:163], v228 offset:16384
    v_mfma_f32_16x16x32_bf16 v[100:103], a[228:231], v[216:219], v[100:103]
    ds_read_b128 v[148:151], v228 offset:48128
    v_mfma_f32_16x16x32_bf16 v[124:127], a[236:239], v[220:223], v[124:127]
    ds_read_b128 v[140:143], v228 offset:52224
    v_mfma_f32_16x16x32_bf16 v[96:99], a[224:227], v[216:219], v[96:99]
    ds_read_b128 v[144:147], v228 offset:47104
    v_mfma_f32_16x16x32_bf16 v[120:123], a[232:235], v[220:223], v[120:123]
    ds_read_b128 v[128:131], v226 offset:0
    ds_read_b128 v[136:139], v228 offset:51200
    ds_read_b128 v[132:135], v226 offset:1024
    s_waitcnt lgkmcnt(9)
    v_pk_add_f32 v[104:105], v[104:105], v[168:169]
    s_waitcnt lgkmcnt(8)
    v_pk_add_f32 v[100:101], v[100:101], v[164:165]
    v_pk_add_f32 v[102:103], v[102:103], v[166:167]
    v_pk_mul_f32 v[100:101], v[100:101], v[8:9] op_sel:[0,1] op_sel_hi:[1,1]
    v_pk_mul_f32 v[104:105], v[104:105], v[8:9] op_sel:[0,1] op_sel_hi:[1,1]
    v_cvt_pk_bf16_f32 v104, v104, v105
    s_waitcnt lgkmcnt(7)
    v_pk_add_f32 v[110:111], v[110:111], v[174:175]
    v_pk_mul_f32 v[110:111], v[110:111], v[8:9] op_sel:[0,1] op_sel_hi:[1,1]
    s_waitcnt lgkmcnt(6)
    v_pk_add_f32 v[98:99], v[98:99], v[162:163]
    v_pk_add_f32 v[96:97], v[96:97], v[160:161]
    v_pk_add_f32 v[108:109], v[108:109], v[172:173]
    v_pk_mul_f32 v[108:109], v[108:109], v[8:9] op_sel:[0,1] op_sel_hi:[1,1]
    v_pk_mul_f32 v[96:97], v[96:97], v[8:9] op_sel:[0,1] op_sel_hi:[1,1]
    v_cvt_pk_bf16_f32 v96, v96, v97
    v_pk_add_f32 v[106:107], v[106:107], v[170:171]
    v_pk_mul_f32 v[106:107], v[106:107], v[8:9] op_sel:[0,1] op_sel_hi:[1,1]
    v_cvt_pk_bf16_f32 v105, v106, v107
    v_cvt_pk_bf16_f32 v106, v108, v109
    v_cvt_pk_bf16_f32 v107, v110, v111
    v_pk_mul_f32 v[98:99], v[98:99], v[8:9] op_sel:[0,1] op_sel_hi:[1,1]
    v_permlane16_swap_b32 v104, v106
    v_cvt_pk_bf16_f32 v97, v98, v99
    v_cvt_pk_bf16_f32 v98, v100, v101
    v_permlane16_swap_b32 v105, v107
    v_pk_mul_f32 v[102:103], v[102:103], v[8:9] op_sel:[0,1] op_sel_hi:[1,1]
    v_cvt_pk_bf16_f32 v99, v102, v103
    v_permlane16_swap_b32 v96, v98
    s_waitcnt lgkmcnt(2)
    v_pk_add_f32 v[122:123], v[122:123], v[130:131]
    v_permlane16_swap_b32 v97, v99
    v_cndmask_b32_dpp v108, v96, v104, vcc quad_perm:[1,0,3,2] row_mask:0xf bank_mask:0xf
    v_cndmask_b32_dpp v110, v98, v106, vcc quad_perm:[1,0,3,2] row_mask:0xf bank_mask:0xf
    v_cndmask_b32_dpp v109, v97, v105, vcc quad_perm:[1,0,3,2] row_mask:0xf bank_mask:0xf
    v_cndmask_b32_dpp v111, v99, v107, vcc quad_perm:[1,0,3,2] row_mask:0xf bank_mask:0xf
    s_not_b64 vcc, vcc
    v_cndmask_b32_dpp v101, v105, v97, vcc quad_perm:[1,0,3,2] row_mask:0xf bank_mask:0xf
    buffer_store_dwordx4 v[108:111], v230, s[16:19], s45 offen offset:256 sc0 sc1 nt
    v_cndmask_b32_dpp v102, v106, v98, vcc quad_perm:[1,0,3,2] row_mask:0xf bank_mask:0xf
    v_cndmask_b32_dpp v100, v104, v96, vcc quad_perm:[1,0,3,2] row_mask:0xf bank_mask:0xf
    v_cndmask_b32_dpp v103, v107, v99, vcc quad_perm:[1,0,3,2] row_mask:0xf bank_mask:0xf
    buffer_store_dwordx4 v[100:103], v230, s[16:19], s45 offen offset:0 sc0 sc1 nt
    s_waitcnt lgkmcnt(1)
    v_pk_add_f32 v[138:139], v[138:139], v[146:147]
    v_pk_add_f32 v[142:143], v[142:143], v[150:151]
    v_pk_add_f32 v[120:121], v[120:121], v[128:129]
    v_pk_add_f32 v[136:137], v[136:137], v[144:145]
    v_pk_add_f32 v[120:121], v[120:121], v[136:137]
    v_pk_mul_f32 v[120:121], v[120:121], v[10:11] op_sel_hi:[1,0]
    v_cvt_pk_bf16_f32 v120, v120, v121
    v_pk_add_f32 v[140:141], v[140:141], v[148:149]
    s_waitcnt lgkmcnt(0)
    v_pk_add_f32 v[126:127], v[126:127], v[134:135]
    v_pk_add_f32 v[126:127], v[126:127], v[142:143]
    v_pk_mul_f32 v[126:127], v[126:127], v[10:11] op_sel_hi:[1,0]
    v_pk_add_f32 v[124:125], v[124:125], v[132:133]
    v_pk_add_f32 v[124:125], v[124:125], v[140:141]
    v_pk_mul_f32 v[124:125], v[124:125], v[10:11] op_sel_hi:[1,0]
    v_pk_add_f32 v[122:123], v[122:123], v[138:139]
    v_pk_mul_f32 v[122:123], v[122:123], v[10:11] op_sel_hi:[1,0]
    v_cvt_pk_bf16_f32 v121, v122, v123
    v_cvt_pk_bf16_f32 v123, v126, v127
    v_cvt_pk_bf16_f32 v122, v124, v125
    s_nop 0
    v_permlane16_swap_b32 v121, v123
    v_permlane16_swap_b32 v120, v122
    buffer_store_dwordx4 v[120:123], v231, s[16:19], s51 offen offset:64 sc0 sc1 nt
    s_branch L_epi
L_tail0:
    s_mov_b32 s53, 0x2b800000
    ds_read_b64_tr_b16 a[240:241], v2 offset:0
    ds_read_b64_tr_b16 a[250:251], v2 offset:4608
    ds_read_b64_tr_b16 a[242:243], v2 offset:4096
    ds_read_b64_tr_b16 a[254:255], v2 offset:4864
    ds_read_b64_tr_b16 a[252:253], v2 offset:768
    ds_read_b64_tr_b16 a[246:247], v2 offset:4352
    ds_read_b64_tr_b16 a[244:245], v2 offset:256
    ds_read_b64_tr_b16 a[248:249], v2 offset:512
    v_bitop3_b32 v243, s99, v68, v72 bitop3:0x7e
    v_bitop3_b32 v242, s99, v52, v56 bitop3:0x7e
    v_bitop3_b32 v241, s99, v36, v40 bitop3:0x7e
    v_bitop3_b32 v241, v44, v33, v241 bitop3:0xbe
    v_bitop3_b32 v240, s99, v20, v24 bitop3:0x7e
    v_bitop3_b32 v244, s99, v84, v88 bitop3:0x7e
    v_bitop3_b32 v245, s99, v100, v104 bitop3:0x7e
    v_bitop3_b32 v241, v37, v41, v241 bitop3:0xbe
    v_bitop3_b32 v241, v45, v34, v241 bitop3:0xbe
    v_bitop3_b32 v241, v38, v42, v241 bitop3:0xbe
    v_bitop3_b32 v240, v28, v17, v240 bitop3:0xbe
    v_bitop3_b32 v243, v76, v65, v243 bitop3:0xbe
    v_bitop3_b32 v243, v69, v73, v243 bitop3:0xbe
    v_bitop3_b32 v243, v77, v66, v243 bitop3:0xbe
    v_bitop3_b32 v243, v70, v74, v243 bitop3:0xbe
    v_bitop3_b32 v240, v21, v25, v240 bitop3:0xbe
    v_bitop3_b32 v240, v29, v18, v240 bitop3:0xbe
    v_bitop3_b32 v240, v22, v26, v240 bitop3:0xbe
    v_bitop3_b32 v245, v108, v97, v245 bitop3:0xbe
    v_bitop3_b32 v245, v101, v105, v245 bitop3:0xbe
    v_bitop3_b32 v245, v109, v98, v245 bitop3:0xbe
    v_bitop3_b32 v245, v102, v106, v245 bitop3:0xbe
    v_bitop3_b32 v244, v92, v81, v244 bitop3:0xbe
    v_bitop3_b32 v244, v85, v89, v244 bitop3:0xbe
    v_bitop3_b32 v244, v93, v82, v244 bitop3:0xbe
    v_bitop3_b32 v244, v86, v90, v244 bitop3:0xbe
    v_min3_u32 v243, v243, v244, v245
    v_bitop3_b32 v246, s99, v116, v120 bitop3:0x7e
    v_bitop3_b32 v246, v124, v113, v246 bitop3:0xbe
    v_bitop3_b32 v246, v117, v121, v246 bitop3:0xbe
    v_bitop3_b32 v246, v125, v114, v246 bitop3:0xbe
    v_bitop3_b32 v246, v118, v122, v246 bitop3:0xbe
    v_bitop3_b32 v246, v126, v115, v246 bitop3:0xbe
    v_lshlrev_b32 v13, 4, v0
    v_add_u32 v224, s58, v13
    v_add_u32 v225, 65536, v224
    v_add_u32 v226, 131072, v224
    v_bitop3_b32 v242, v60, v49, v242 bitop3:0xbe
    v_bitop3_b32 v242, v53, v57, v242 bitop3:0xbe
    v_bitop3_b32 v242, v61, v50, v242 bitop3:0xbe
    v_bitop3_b32 v242, v54, v58, v242 bitop3:0xbe
    v_min3_u32 v240, v240, v241, v242
    v_min3_u32 v240, v240, v243, v246
    v_cmp_gt_u32 s[96:97], s98, v240
    s_waitcnt lgkmcnt(9)
    ds_read_b64_tr_b16 a[234:235], v2 offset:5632
    ds_read_b64_tr_b16 a[228:229], v2 offset:1280
    s_waitcnt lgkmcnt(10)
    ds_read_b64_tr_b16 a[238:239], v2 offset:5888
    ds_read_b64_tr_b16 a[236:237], v2 offset:1792
    ds_read_b64_tr_b16 a[224:225], v2 offset:1024
    ds_read_b64_tr_b16 a[230:231], v2 offset:5376
    ds_read_b64_tr_b16 a[226:227], v2 offset:5120
    ds_read_b64_tr_b16 a[232:233], v2 offset:1536
    s_waitcnt vmcnt(0)
    s_waitcnt lgkmcnt(13)
    v_mfma_f32_16x16x32_bf16 a[0:3], a[240:243], v[184:187], a[0:3]
    s_waitcnt lgkmcnt(9)
    v_add_f32 v7, v169, v7
    v_add_f32 v7, v170, v7
    v_mfma_f32_16x16x32_bf16 a[4:7], a[244:247], v[184:187], a[4:7]
    s_waitcnt lgkmcnt(8)
    v_add_f32 v7, v171, v7
    v_permlane32_swap_b32 v4, v5
    v_mfma_f32_16x16x32_bf16 a[8:11], a[248:251], v[184:187], a[8:11]
    v_add_f32 v4, v4, v5
    v_permlane32_swap_b32 v6, v7
    v_mfma_f32_16x16x32_bf16 a[12:15], a[252:255], v[184:187], a[12:15]
    s_waitcnt lgkmcnt(4)
    v_add_f32 v6, v6, v7
    ds_write_b128 v224, a[0:3] offset:0
    s_nop 0
    v_permlane16_swap_b32 v4, v6
    s_nop 2
    ds_write_b128 v224, a[12:15] offset:3072
    v_add_f32 v4, v4, v6
    v_mfma_f32_16x16x32_bf16 v[28:31], a[236:239], v[184:187], v[28:31]
    s_waitcnt lgkmcnt(2)
    s_lshl_b32 s50, s29, 7
    s_mov_b32 vcc_lo, 0x55555555
    ds_write_b128 v224, a[8:11] offset:2048
    v_mfma_f32_16x16x32_bf16 v[24:27], a[232:235], v[184:187], v[24:27]
    s_mov_b32 s52, 0x53800000
    v_xor_b32 v229, 0x2000, v226
    v_mfma_f32_16x16x32_bf16 v[16:19], a[224:227], v[184:187], v[16:19]
    ds_write_b32 v226, v4 offset:2048
    v_mfma_f32_16x16x32_bf16 v[20:23], a[228:231], v[184:187], v[20:23]
    ds_write_b128 v224, a[4:7] offset:1024
    v_xor_b32 v227, 0x2000, v224
    s_movk_i32 s49, 0xff40
    s_mov_b32 vcc_hi, 0x55555555
    s_mov_b32 s51, 0xc000
    v_and_b32 v13, 15, v0
    v_xor_b32 v228, 0x2000, v225
    v_lshlrev_b32 v233, 8, v13
    v_bfe_u32 v13, v0, 4, 1
    v_lshl_add_u32 v233, v13, 5, v233
    v_lshrrev_b32 v13, 5, v0
    v_lshl_add_u32 v233, v13, 4, v233
    v_and_b32 v13, 1, v0
    v_add_u32 v231, s50, v233
    v_mad_i32_i24 v230, v13, s49, v231
    v_cvt_pk_bf16_f32 v199, v166, v167
    v_mfma_f32_16x16x32_bf16 a[20:23], a[244:247], v[190:193], a[20:23]
    v_cvt_pk_bf16_f32 v205, v170, v171
    v_cvt_pk_bf16_f32 v204, v168, v169
    v_mfma_f32_16x16x32_bf16 a[28:31], a[252:255], v[190:193], a[28:31]
    v_cvt_pk_bf16_f32 v210, v172, v173
    v_cvt_pk_bf16_f32 v211, v174, v175
    v_mfma_f32_16x16x32_bf16 a[16:19], a[240:243], v[190:193], a[16:19]
    s_nop 1
    ds_write_b128 v224, a[20:23] offset:17408
    v_mfma_f32_16x16x32_bf16 a[24:27], a[248:251], v[190:193], a[24:27]
    s_nop 3
    ds_write_b128 v224, a[16:19] offset:16384
    v_mfma_f32_16x16x32_bf16 a[32:35], a[240:243], v[196:199], a[32:35]
    v_add_f32 v8, v172, v8
    v_add_f32 v8, v173, v8
    v_mfma_f32_16x16x32_bf16 a[36:39], a[244:247], v[196:199], a[36:39]
    ds_write_b128 v224, a[24:27] offset:18432
    v_mfma_f32_16x16x32_bf16 a[44:47], a[252:255], v[196:199], a[44:47]
    v_add_f32 v8, v174, v8
    v_add_f32 v8, v175, v8
    v_mfma_f32_16x16x32_bf16 a[40:43], a[248:251], v[196:199], a[40:43]
    ds_write_b128 v224, a[28:31] offset:19456
    v_add_f32 v9, v176, v9
    v_mfma_f32_16x16x32_bf16 a[48:51], a[240:243], v[202:205], a[48:51]
    s_waitcnt lgkmcnt(4)
    s_barrier
    s_nop 2
    ds_write_b128 v224, a[40:43] offset:34816
    v_mov_b32 v11, v10
    v_mfma_f32_16x16x32_bf16 a[52:55], a[244:247], v[202:205], a[52:55]
    s_nop 0
    v_permlane32_swap_b32 v10, v11
    v_add_f32 v10, v10, v11
    ds_read_b32 v232, v229 offset:2048
    ds_read_b128 v[128:131], v227 offset:0
    v_mfma_f32_16x16x32_bf16 a[60:63], a[252:255], v[202:205], a[60:63]
    ds_read_b128 v[140:143], v227 offset:3072
    v_mfma_f32_16x16x32_bf16 a[56:59], a[248:251], v[202:205], a[56:59]
    ds_read_b128 v[136:139], v227 offset:2048
    v_mfma_f32_16x16x32_bf16 a[76:79], a[252:255], v[208:211], a[76:79]
    ds_read_b128 v[132:135], v227 offset:1024
    v_mfma_f32_16x16x32_bf16 a[72:75], a[248:251], v[208:211], a[72:75]
    ds_write_b128 v224, a[44:47] offset:35840
    v_mfma_f32_16x16x32_bf16 a[64:67], a[240:243], v[208:211], a[64:67]
    v_exp_f32 v178, v178
    v_mfma_f32_16x16x32_bf16 a[68:71], a[244:247], v[208:211], a[68:71]
    ds_write_b128 v224, a[32:35] offset:32768
    s_waitcnt lgkmcnt(6)
    v_add_f32 v232, v232, v4
    v_rcp_f32 v4, v232
    s_waitcnt lgkmcnt(5)
    v_pk_add_f32 v[16:17], v[16:17], v[128:129]
    v_mov_b32 v6, v4
    v_pk_add_f32 v[18:19], v[18:19], v[130:131]
    s_waitcnt lgkmcnt(4)
    v_pk_add_f32 v[28:29], v[28:29], v[140:141]
    v_permlane16_swap_b32 v4, v6
    v_mov_b32 v5, v4
    v_mov_b32 v7, v6
    s_waitcnt lgkmcnt(3)
    v_pk_add_f32 v[26:27], v[26:27], v[138:139]
    v_permlane32_swap_b32 v4, v5
    v_permlane32_swap_b32 v6, v7
    v_pk_add_f32 v[24:25], v[24:25], v[136:137]
    v_pk_mul_f32 v[24:25], v[24:25], v[4:5] op_sel_hi:[1,0]
    v_cvt_pk_bf16_f32 v24, v24, v25
    v_pk_add_f32 v[30:31], v[30:31], v[142:143]
    v_pk_mul_f32 v[30:31], v[30:31], v[4:5] op_sel_hi:[1,0]
    s_waitcnt lgkmcnt(2)
    v_pk_add_f32 v[22:23], v[22:23], v[134:135]
    v_pk_mul_f32 v[22:23], v[22:23], v[4:5] op_sel_hi:[1,0]
    v_pk_mul_f32 v[18:19], v[18:19], v[4:5] op_sel_hi:[1,0]
    v_pk_mul_f32 v[16:17], v[16:17], v[4:5] op_sel_hi:[1,0]
    v_cvt_pk_bf16_f32 v16, v16, v17
    v_cvt_pk_bf16_f32 v17, v18, v19
    v_pk_mul_f32 v[26:27], v[26:27], v[4:5] op_sel_hi:[1,0]
    v_pk_mul_f32 v[28:29], v[28:29], v[4:5] op_sel_hi:[1,0]
    v_cvt_pk_bf16_f32 v19, v22, v23
    v_cvt_pk_bf16_f32 v25, v26, v27
    v_cvt_pk_bf16_f32 v27, v30, v31
    v_cvt_pk_bf16_f32 v26, v28, v29
    v_pk_add_f32 v[20:21], v[20:21], v[132:133]
    v_pk_mul_f32 v[20:21], v[20:21], v[4:5] op_sel_hi:[1,0]
    v_cvt_pk_bf16_f32 v18, v20, v21
    v_permlane16_swap_b32 v25, v27
    v_permlane16_swap_b32 v24, v26
    v_permlane16_swap_b32 v16, v18
    v_permlane16_swap_b32 v17, v19
    ds_write_b128 v224, a[36:39] offset:33792
    v_cndmask_b32_dpp v20, v24, v16, vcc quad_perm:[1,0,3,2] row_mask:0xf bank_mask:0xf
    v_cndmask_b32_dpp v21, v25, v17, vcc quad_perm:[1,0,3,2] row_mask:0xf bank_mask:0xf
    v_cndmask_b32_dpp v22, v26, v18, vcc quad_perm:[1,0,3,2] row_mask:0xf bank_mask:0xf
    v_cndmask_b32_dpp v23, v27, v19, vcc quad_perm:[1,0,3,2] row_mask:0xf bank_mask:0xf
    s_not_b64 vcc, vcc
    v_cndmask_b32_dpp v30, v18, v26, vcc quad_perm:[1,0,3,2] row_mask:0xf bank_mask:0xf
    v_cndmask_b32_dpp v29, v17, v25, vcc quad_perm:[1,0,3,2] row_mask:0xf bank_mask:0xf
    v_cndmask_b32_dpp v31, v19, v27, vcc quad_perm:[1,0,3,2] row_mask:0xf bank_mask:0xf
    buffer_store_dwordx4 v[20:23], v230, s[16:19], s40 offen offset:0 sc0 sc1 nt
    v_cndmask_b32_dpp v28, v16, v24, vcc quad_perm:[1,0,3,2] row_mask:0xf bank_mask:0xf
    buffer_store_dwordx4 v[28:31], v230, s[16:19], s40 offen offset:256 sc0 sc1 nt
    ds_write_b128 v224, a[48:51] offset:49152
    v_mfma_f32_16x16x32_bf16 v[40:43], a[232:235], v[190:193], v[40:43]
    ds_write_b128 v224, a[56:59] offset:51200
    v_mfma_f32_16x16x32_bf16 v[44:47], a[236:239], v[190:193], v[44:47]
    v_exp_f32 v179, v179
    ds_write_b128 v224, a[52:55] offset:50176
    v_mfma_f32_16x16x32_bf16 v[36:39], a[228:231], v[190:193], v[36:39]
    v_cvt_pk_bf16_f32 v217, v178, v179
    v_exp_f32 v177, v177
    v_mfma_f32_16x16x32_bf16 v[32:35], a[224:227], v[190:193], v[32:35]
    v_add_f32 v9, v177, v9
    v_add_f32 v9, v178, v9
    v_add_f32 v9, v179, v9
    ds_write_b128 v224, a[60:63] offset:52224
    s_nop 0
    v_permlane32_swap_b32 v8, v9
    v_add_f32 v8, v8, v9
    s_waitcnt lgkmcnt(4)
    s_barrier
    ds_write_b128 v225, a[76:79] offset:3072
    v_permlane16_swap_b32 v8, v10
    v_add_f32 v10, v8, v10
    v_min_f32 v15, v232, v10
    v_cmp_nle_f32 s[54:55], s53, v15
    v_add_f32 v11, v232, v10
    v_cndmask_b32 v11, v11, -1, s[96:97]
    v_cndmask_b32 v11, v11, -1, s[54:55]
    ds_read_b128 v[152:155], v227 offset:18432
    v_mfma_f32_16x16x32_bf16 v[56:59], a[232:235], v[196:199], v[56:59]
    ds_read_b128 v[148:151], v227 offset:17408
    v_mfma_f32_16x16x32_bf16 v[48:51], a[224:227], v[196:199], v[48:51]
    ds_read_b128 v[144:147], v227 offset:16384
    v_mfma_f32_16x16x32_bf16 v[60:63], a[236:239], v[196:199], v[60:63]
    ds_read_b128 v[156:159], v227 offset:19456
    v_mfma_f32_16x16x32_bf16 v[52:55], a[228:231], v[196:199], v[52:55]
    ds_read_b128 v[160:163], v227 offset:32768
    v_cvt_pk_bf16_f32 v216, v176, v177
    ds_read_b128 v[168:171], v227 offset:34816
    ds_read_b128 v[172:175], v227 offset:35840
    v_mfma_f32_16x16x32_bf16 a[92:95], a[252:255], v[214:217], a[92:95]
    ds_read_b128 v[164:167], v227 offset:33792
    v_mfma_f32_16x16x32_bf16 a[88:91], a[248:251], v[214:217], a[88:91]
    ds_write_b64 v226, v[10:11] offset:2056
    s_waitcnt lgkmcnt(8)
    v_pk_add_f32 v[40:41], v[40:41], v[152:153]
    ds_write_b128 v225, a[68:71] offset:1024
    s_waitcnt lgkmcnt(7)
    v_pk_add_f32 v[34:35], v[34:35], v[146:147]
    v_pk_mul_f32 v[34:35], v[34:35], v[4:5] op_sel:[0,1] op_sel_hi:[1,1]
    s_waitcnt lgkmcnt(6)
    v_pk_add_f32 v[44:45], v[44:45], v[156:157]
    v_pk_mul_f32 v[44:45], v[44:45], v[4:5] op_sel:[0,1] op_sel_hi:[1,1]
    v_pk_add_f32 v[38:39], v[38:39], v[150:151]
    ds_write_b128 v225, a[64:67] offset:0
    v_pk_add_f32 v[46:47], v[46:47], v[158:159]
    v_pk_mul_f32 v[40:41], v[40:41], v[4:5] op_sel:[0,1] op_sel_hi:[1,1]
    v_pk_add_f32 v[42:43], v[42:43], v[154:155]
    v_pk_add_f32 v[32:33], v[32:33], v[144:145]
    ds_write_b128 v225, a[72:75] offset:2048
    v_pk_mul_f32 v[32:33], v[32:33], v[4:5] op_sel:[0,1] op_sel_hi:[1,1]
    v_cvt_pk_bf16_f32 v32, v32, v33
    v_cvt_pk_bf16_f32 v33, v34, v35
    v_pk_mul_f32 v[38:39], v[38:39], v[4:5] op_sel:[0,1] op_sel_hi:[1,1]
    v_cvt_pk_bf16_f32 v35, v38, v39
    v_pk_mul_f32 v[46:47], v[46:47], v[4:5] op_sel:[0,1] op_sel_hi:[1,1]
    v_pk_add_f32 v[36:37], v[36:37], v[148:149]
    v_permlane16_swap_b32 v33, v35
    v_pk_mul_f32 v[36:37], v[36:37], v[4:5] op_sel:[0,1] op_sel_hi:[1,1]
    v_cvt_pk_bf16_f32 v34, v36, v37
    v_pk_mul_f32 v[42:43], v[42:43], v[4:5] op_sel:[0,1] op_sel_hi:[1,1]
    v_cvt_pk_bf16_f32 v40, v40, v41
    v_permlane16_swap_b32 v32, v34
    v_cvt_pk_bf16_f32 v41, v42, v43
    v_cvt_pk_bf16_f32 v42, v44, v45
    v_cvt_pk_bf16_f32 v43, v46, v47
    s_waitcnt lgkmcnt(6)
    v_pk_add_f32 v[58:59], v[58:59], v[170:171]
    v_permlane16_swap_b32 v40, v42
    v_permlane16_swap_b32 v41, v43
    s_waitcnt lgkmcnt(5)
    v_pk_add_f32 v[62:63], v[62:63], v[174:175]
    v_cndmask_b32_dpp v46, v34, v42, vcc quad_perm:[1,0,3,2] row_mask:0xf bank_mask:0xf
    v_cndmask_b32_dpp v44, v32, v40, vcc quad_perm:[1,0,3,2] row_mask:0xf bank_mask:0xf
    v_cndmask_b32_dpp v47, v35, v43, vcc quad_perm:[1,0,3,2] row_mask:0xf bank_mask:0xf
    v_cndmask_b32_dpp v45, v33, v41, vcc quad_perm:[1,0,3,2] row_mask:0xf bank_mask:0xf
    s_not_b64 vcc, vcc
    v_cndmask_b32_dpp v39, v43, v35, vcc quad_perm:[1,0,3,2] row_mask:0xf bank_mask:0xf
    v_cndmask_b32_dpp v36, v40, v32, vcc quad_perm:[1,0,3,2] row_mask:0xf bank_mask:0xf
    buffer_store_dwordx4 v[44:47], v230, s[16:19], s41 offen offset:256 sc0 sc1 nt
    v_cndmask_b32_dpp v38, v42, v34, vcc quad_perm:[1,0,3,2] row_mask:0xf bank_mask:0xf
    v_cndmask_b32_dpp v37, v41, v33, vcc quad_perm:[1,0,3,2] row_mask:0xf bank_mask:0xf
    buffer_store_dwordx4 v[36:39], v230, s[16:19], s41 offen offset:0 sc0 sc1 nt
    v_pk_mul_f32 v[62:63], v[62:63], v[6:7] op_sel_hi:[1,0]
    v_pk_add_f32 v[56:57], v[56:57], v[168:169]
    v_pk_mul_f32 v[56:57], v[56:57], v[6:7] op_sel_hi:[1,0]
    v_pk_add_f32 v[50:51], v[50:51], v[162:163]
    v_pk_mul_f32 v[50:51], v[50:51], v[6:7] op_sel_hi:[1,0]
    v_pk_add_f32 v[48:49], v[48:49], v[160:161]
    v_pk_mul_f32 v[48:49], v[48:49], v[6:7] op_sel_hi:[1,0]
    v_cvt_pk_bf16_f32 v48, v48, v49
    s_waitcnt lgkmcnt(4)
    v_pk_add_f32 v[52:53], v[52:53], v[164:165]
    v_pk_mul_f32 v[52:53], v[52:53], v[6:7] op_sel_hi:[1,0]
    v_pk_add_f32 v[60:61], v[60:61], v[172:173]
    v_pk_mul_f32 v[60:61], v[60:61], v[6:7] op_sel_hi:[1,0]
    v_cvt_pk_bf16_f32 v49, v50, v51
    v_cvt_pk_bf16_f32 v50, v52, v53
    v_pk_add_f32 v[54:55], v[54:55], v[166:167]
    v_pk_mul_f32 v[54:55], v[54:55], v[6:7] op_sel_hi:[1,0]
    v_cvt_pk_bf16_f32 v51, v54, v55
    v_pk_mul_f32 v[58:59], v[58:59], v[6:7] op_sel_hi:[1,0]
    v_permlane16_swap_b32 v48, v50
    v_permlane16_swap_b32 v49, v51
    v_cvt_pk_bf16_f32 v56, v56, v57
    v_cvt_pk_bf16_f32 v57, v58, v59
    v_cvt_pk_bf16_f32 v58, v60, v61
    v_cvt_pk_bf16_f32 v59, v62, v63
    v_mfma_f32_16x16x32_bf16 a[80:83], a[240:243], v[214:217], a[80:83]
    s_nop 0
    v_permlane16_swap_b32 v57, v59
    v_permlane16_swap_b32 v56, v58
    ds_write_b128 v225, a[92:95] offset:19456
    v_cndmask_b32_dpp v55, v59, v51, vcc quad_perm:[1,0,3,2] row_mask:0xf bank_mask:0xf
    v_cndmask_b32_dpp v52, v56, v48, vcc quad_perm:[1,0,3,2] row_mask:0xf bank_mask:0xf
    v_cndmask_b32_dpp v54, v58, v50, vcc quad_perm:[1,0,3,2] row_mask:0xf bank_mask:0xf
    v_cndmask_b32_dpp v53, v57, v49, vcc quad_perm:[1,0,3,2] row_mask:0xf bank_mask:0xf
    buffer_store_dwordx4 v[52:55], v230, s[16:19], s42 offen offset:0 sc0 sc1 nt
    s_not_b64 vcc, vcc
    v_cndmask_b32_dpp v62, v50, v58, vcc quad_perm:[1,0,3,2] row_mask:0xf bank_mask:0xf
    v_cndmask_b32_dpp v61, v49, v57, vcc quad_perm:[1,0,3,2] row_mask:0xf bank_mask:0xf
    v_cndmask_b32_dpp v63, v51, v59, vcc quad_perm:[1,0,3,2] row_mask:0xf bank_mask:0xf
    v_cndmask_b32_dpp v60, v48, v56, vcc quad_perm:[1,0,3,2] row_mask:0xf bank_mask:0xf
    buffer_store_dwordx4 v[60:63], v230, s[16:19], s42 offen offset:256 sc0 sc1 nt
    ds_write_b128 v225, a[80:83] offset:16384
    v_mfma_f32_16x16x32_bf16 v[76:79], a[236:239], v[202:205], v[76:79]
    ds_write_b128 v225, a[88:91] offset:18432
    v_mfma_f32_16x16x32_bf16 v[64:67], a[224:227], v[202:205], v[64:67]
    ds_write_b128 v225, a[100:103] offset:50176
    v_mfma_f32_16x16x32_bf16 v[72:75], a[232:235], v[202:205], v[72:75]
    v_mfma_f32_16x16x32_bf16 v[68:71], a[228:231], v[202:205], v[68:71]
    ds_write_b128 v225, a[108:111] offset:52224
    v_mfma_f32_16x16x32_bf16 v[88:91], a[232:235], v[208:211], v[88:91]
    v_mfma_f32_16x16x32_bf16 v[80:83], a[224:227], v[208:211], v[80:83]
    ds_write_b128 v225, a[104:107] offset:51200
    v_mfma_f32_16x16x32_bf16 v[84:87], a[228:231], v[208:211], v[84:87]
    v_mfma_f32_16x16x32_bf16 v[92:95], a[236:239], v[208:211], v[92:95]
    ds_write_b128 v226, v[124:127] offset:1024
    v_mfma_f32_16x16x32_bf16 v[104:107], a[232:235], v[214:217], v[104:107]
    ds_write_b128 v226, v[120:123] offset:0
    s_waitcnt lgkmcnt(8)
    s_barrier
    v_mfma_f32_16x16x32_bf16 v[100:103], a[228:231], v[214:217], v[100:103]
    v_mfma_f32_16x16x32_bf16 v[108:111], a[236:239], v[214:217], v[108:111]
    ds_read_b64 v[238:239], v229 offset:6152
    ds_read_b64 v[236:237], v226 offset:6152
    ds_read_b64 v[234:235], v229 offset:2056
    ds_read_b128 v[128:131], v227 offset:49152
    v_mfma_f32_16x16x32_bf16 v[96:99], a[224:227], v[214:217], v[96:99]
    ds_read_b128 v[136:139], v227 offset:51200
    v_mfma_f32_16x16x32_bf16 a[84:87], a[244:247], v[214:217], a[84:87]
    ds_read_b128 v[140:143], v227 offset:52224
    ds_read_b128 v[132:135], v227 offset:50176
    ds_read_b128 v[144:147], v228 offset:0
    ds_read_b128 v[156:159], v228 offset:3072
    ds_read_b128 v[152:155], v228 offset:2048
    ds_read_b128 v[148:151], v228 offset:1024
    s_waitcnt lgkmcnt(9)
    v_pk_add_f32 v[236:237], v[236:237], v[238:239]
    ds_write_b128 v225, a[84:87] offset:17408
    s_waitcnt lgkmcnt(9)
    v_pk_add_f32 v[10:11], v[10:11], v[234:235]
    v_add_f32 v11, v11, v237
    s_waitcnt lgkmcnt(7)
    v_pk_add_f32 v[74:75], v[74:75], v[138:139]
    v_add_f32_dpp v10, v236, v10 quad_perm:[0,1,2,3] row_mask:0xa bank_mask:0xf
    v_rcp_f32 v8, v10
    ds_write_b128 v225, a[96:99] offset:49152
    v_mov_b32 v10, v8
    v_pk_add_f32 v[64:65], v[64:65], v[128:129]
    s_waitcnt lgkmcnt(7)
    v_pk_add_f32 v[76:77], v[76:77], v[140:141]
    v_permlane16_swap_b32 v8, v10
    v_mov_b32 v9, v8
    s_waitcnt lgkmcnt(6)
    v_pk_add_f32 v[70:71], v[70:71], v[134:135]
    v_pk_mul_f32 v[70:71], v[70:71], v[6:7] op_sel:[0,1] op_sel_hi:[1,1]
    v_permlane32_swap_b32 v8, v9
    v_pk_mul_f32 v[76:77], v[76:77], v[6:7] op_sel:[0,1] op_sel_hi:[1,1]
    v_pk_add_f32 v[68:69], v[68:69], v[132:133]
    v_pk_mul_f32 v[68:69], v[68:69], v[6:7] op_sel:[0,1] op_sel_hi:[1,1]
    v_pk_add_f32 v[78:79], v[78:79], v[142:143]
    v_pk_mul_f32 v[78:79], v[78:79], v[6:7] op_sel:[0,1] op_sel_hi:[1,1]
    v_pk_mul_f32 v[74:75], v[74:75], v[6:7] op_sel:[0,1] op_sel_hi:[1,1]
    v_pk_mul_f32 v[64:65], v[64:65], v[6:7] op_sel:[0,1] op_sel_hi:[1,1]
    v_cvt_pk_bf16_f32 v64, v64, v65
    v_pk_add_f32 v[72:73], v[72:73], v[136:137]
    v_pk_mul_f32 v[72:73], v[72:73], v[6:7] op_sel:[0,1] op_sel_hi:[1,1]
    v_cvt_pk_bf16_f32 v72, v72, v73
    v_cvt_pk_bf16_f32 v73, v74, v75
    v_cvt_pk_bf16_f32 v74, v76, v77
    v_cvt_pk_bf16_f32 v75, v78, v79
    v_pk_add_f32 v[66:67], v[66:67], v[130:131]
    v_pk_mul_f32 v[66:67], v[66:67], v[6:7] op_sel:[0,1] op_sel_hi:[1,1]
    v_cvt_pk_bf16_f32 v65, v66, v67
    v_cvt_pk_bf16_f32 v67, v70, v71
    v_permlane16_swap_b32 v73, v75
    v_cvt_pk_bf16_f32 v66, v68, v69
    v_permlane16_swap_b32 v65, v67
    v_permlane16_swap_b32 v72, v74
    v_permlane16_swap_b32 v64, v66
    v_cndmask_b32_dpp v79, v67, v75, vcc quad_perm:[1,0,3,2] row_mask:0xf bank_mask:0xf
    v_cndmask_b32_dpp v77, v65, v73, vcc quad_perm:[1,0,3,2] row_mask:0xf bank_mask:0xf
    v_cndmask_b32_dpp v76, v64, v72, vcc quad_perm:[1,0,3,2] row_mask:0xf bank_mask:0xf
    v_cndmask_b32_dpp v78, v66, v74, vcc quad_perm:[1,0,3,2] row_mask:0xf bank_mask:0xf
    buffer_store_dwordx4 v[76:79], v230, s[16:19], s43 offen offset:256 sc0 sc1 nt
    s_not_b64 vcc, vcc
    v_cndmask_b32_dpp v68, v72, v64, vcc quad_perm:[1,0,3,2] row_mask:0xf bank_mask:0xf
    v_cndmask_b32_dpp v70, v74, v66, vcc quad_perm:[1,0,3,2] row_mask:0xf bank_mask:0xf
    v_cndmask_b32_dpp v71, v75, v67, vcc quad_perm:[1,0,3,2] row_mask:0xf bank_mask:0xf
    v_cndmask_b32_dpp v69, v73, v65, vcc quad_perm:[1,0,3,2] row_mask:0xf bank_mask:0xf
    buffer_store_dwordx4 v[68:71], v230, s[16:19], s43 offen offset:0 sc0 sc1 nt
    s_waitcnt lgkmcnt(5)
    v_pk_add_f32 v[80:81], v[80:81], v[144:145]
    v_pk_mul_f32 v[80:81], v[80:81], v[8:9] op_sel_hi:[1,0]
    s_waitcnt lgkmcnt(3)
    v_pk_add_f32 v[88:89], v[88:89], v[152:153]
    v_pk_mul_f32 v[88:89], v[88:89], v[8:9] op_sel_hi:[1,0]
    v_cvt_pk_bf16_f32 v88, v88, v89
    s_waitcnt lgkmcnt(2)
    v_pk_add_f32 v[84:85], v[84:85], v[148:149]
    v_pk_mul_f32 v[84:85], v[84:85], v[8:9] op_sel_hi:[1,0]
    v_pk_add_f32 v[86:87], v[86:87], v[150:151]
    v_pk_mul_f32 v[86:87], v[86:87], v[8:9] op_sel_hi:[1,0]
    v_pk_add_f32 v[90:91], v[90:91], v[154:155]
    v_pk_mul_f32 v[90:91], v[90:91], v[8:9] op_sel_hi:[1,0]
    v_pk_add_f32 v[92:93], v[92:93], v[156:157]
    v_pk_mul_f32 v[92:93], v[92:93], v[8:9] op_sel_hi:[1,0]
    v_pk_add_f32 v[82:83], v[82:83], v[146:147]
    v_pk_mul_f32 v[82:83], v[82:83], v[8:9] op_sel_hi:[1,0]
    v_pk_add_f32 v[94:95], v[94:95], v[158:159]
    v_pk_mul_f32 v[94:95], v[94:95], v[8:9] op_sel_hi:[1,0]
    v_cvt_pk_bf16_f32 v89, v90, v91
    v_cvt_pk_bf16_f32 v91, v94, v95
    v_cvt_pk_bf16_f32 v90, v92, v93
    v_cvt_pk_bf16_f32 v80, v80, v81
    v_permlane16_swap_b32 v89, v91
    v_cvt_pk_bf16_f32 v81, v82, v83
    v_permlane16_swap_b32 v88, v90
    v_cvt_pk_bf16_f32 v83, v86, v87
    v_cvt_pk_bf16_f32 v82, v84, v85
    s_nop 0
    v_permlane16_swap_b32 v81, v83
    v_permlane16_swap_b32 v80, v82
    s_nop 0
    v_cndmask_b32_dpp v87, v91, v83, vcc quad_perm:[1,0,3,2] row_mask:0xf bank_mask:0xf
    v_cndmask_b32_dpp v86, v90, v82, vcc quad_perm:[1,0,3,2] row_mask:0xf bank_mask:0xf
    v_cndmask_b32_dpp v84, v88, v80, vcc quad_perm:[1,0,3,2] row_mask:0xf bank_mask:0xf
    v_cndmask_b32_dpp v85, v89, v81, vcc quad_perm:[1,0,3,2] row_mask:0xf bank_mask:0xf
    buffer_store_dwordx4 v[84:87], v230, s[16:19], s44 offen offset:0 sc0 sc1 nt
    s_waitcnt lgkmcnt(0)
    s_barrier
    s_not_b64 vcc, vcc
    v_cmp_nge_f32 s[54:55], s52, v11
    s_nop 0
    s_andn2_b64 s[54:55], s[54:55], s[30:31]
    s_cbranch_scc1 L_fallback
    ds_read_b128 v[136:139], v228 offset:49152
    ds_read_b128 v[144:147], v228 offset:53248
    ds_read_b128 v[128:131], v226 offset:4096
    v_cndmask_b32_dpp v93, v81, v89, vcc quad_perm:[1,0,3,2] row_mask:0xf bank_mask:0xf
    ds_read_b128 v[140:143], v228 offset:50176
    ds_read_b128 v[132:135], v226 offset:5120
    v_cndmask_b32_dpp v94, v82, v90, vcc quad_perm:[1,0,3,2] row_mask:0xf bank_mask:0xf
    ds_read_b128 v[148:151], v228 offset:54272
    v_cndmask_b32_dpp v95, v83, v91, vcc quad_perm:[1,0,3,2] row_mask:0xf bank_mask:0xf
    ds_read_b128 v[164:167], v228 offset:17408
    ds_read_b128 v[172:175], v228 offset:19456
    v_cndmask_b32_dpp v92, v80, v88, vcc quad_perm:[1,0,3,2] row_mask:0xf bank_mask:0xf
    ds_read_b128 v[160:163], v228 offset:16384
    ds_read_b128 v[168:171], v228 offset:18432
    buffer_store_dwordx4 v[92:95], v230, s[16:19], s44 offen offset:256 sc0 sc1 nt
    s_waitcnt lgkmcnt(8)
    v_pk_add_f32 v[138:139], v[138:139], v[146:147]
    s_waitcnt lgkmcnt(7)
    v_pk_add_f32 v[112:113], v[112:113], v[128:129]
    v_pk_add_f32 v[114:115], v[114:115], v[130:131]
    v_pk_add_f32 v[114:115], v[114:115], v[138:139]
    v_pk_mul_f32 v[114:115], v[114:115], v[10:11] op_sel_hi:[1,0]
    v_pk_add_f32 v[136:137], v[136:137], v[144:145]
    v_pk_add_f32 v[112:113], v[112:113], v[136:137]
    s_waitcnt lgkmcnt(5)
    v_pk_add_f32 v[116:117], v[116:117], v[132:133]
    v_pk_mul_f32 v[112:113], v[112:113], v[10:11] op_sel_hi:[1,0]
    v_pk_add_f32 v[118:119], v[118:119], v[134:135]
    s_waitcnt lgkmcnt(4)
    v_pk_add_f32 v[142:143], v[142:143], v[150:151]
    v_pk_add_f32 v[140:141], v[140:141], v[148:149]
    v_pk_add_f32 v[116:117], v[116:117], v[140:141]
    s_waitcnt lgkmcnt(3)
    v_pk_add_f32 v[102:103], v[102:103], v[166:167]
    v_pk_add_f32 v[100:101], v[100:101], v[164:165]
    v_pk_mul_f32 v[102:103], v[102:103], v[8:9] op_sel:[0,1] op_sel_hi:[1,1]
    v_pk_mul_f32 v[100:101], v[100:101], v[8:9] op_sel:[0,1] op_sel_hi:[1,1]
    s_waitcnt lgkmcnt(2)
    v_pk_add_f32 v[108:109], v[108:109], v[172:173]
    v_pk_mul_f32 v[108:109], v[108:109], v[8:9] op_sel:[0,1] op_sel_hi:[1,1]
    v_pk_add_f32 v[110:111], v[110:111], v[174:175]
    s_waitcnt lgkmcnt(1)
    v_pk_add_f32 v[96:97], v[96:97], v[160:161]
    v_pk_mul_f32 v[110:111], v[110:111], v[8:9] op_sel:[0,1] op_sel_hi:[1,1]
    v_pk_mul_f32 v[96:97], v[96:97], v[8:9] op_sel:[0,1] op_sel_hi:[1,1]
    s_waitcnt lgkmcnt(0)
    v_pk_add_f32 v[104:105], v[104:105], v[168:169]
    v_pk_add_f32 v[106:107], v[106:107], v[170:171]
    v_cvt_pk_bf16_f32 v96, v96, v97
    v_pk_mul_f32 v[104:105], v[104:105], v[8:9] op_sel:[0,1] op_sel_hi:[1,1]
    v_cvt_pk_bf16_f32 v104, v104, v105
    v_pk_add_f32 v[98:99], v[98:99], v[162:163]
    v_pk_mul_f32 v[98:99], v[98:99], v[8:9] op_sel:[0,1] op_sel_hi:[1,1]
    v_cvt_pk_bf16_f32 v97, v98, v99
    v_cvt_pk_bf16_f32 v99, v102, v103
    v_cvt_pk_bf16_f32 v98, v100, v101
    v_pk_mul_f32 v[106:107], v[106:107], v[8:9] op_sel:[0,1] op_sel_hi:[1,1]
    v_permlane16_swap_b32 v97, v99
    v_permlane16_swap_b32 v96, v98
    v_cvt_pk_bf16_f32 v105, v106, v107
    v_cvt_pk_bf16_f32 v106, v108, v109
    v_cvt_pk_bf16_f32 v107, v110, v111
    v_pk_mul_f32 v[116:117], v[116:117], v[10:11] op_sel_hi:[1,0]
    v_permlane16_swap_b32 v104, v106
    v_permlane16_swap_b32 v105, v107
    v_pk_add_f32 v[118:119], v[118:119], v[142:143]
    v_cndmask_b32_dpp v110, v98, v106, vcc quad_perm:[1,0,3,2] row_mask:0xf bank_mask:0xf
    v_cndmask_b32_dpp v109, v97, v105, vcc quad_perm:[1,0,3,2] row_mask:0xf bank_mask:0xf
    v_cndmask_b32_dpp v111, v99, v107, vcc quad_perm:[1,0,3,2] row_mask:0xf bank_mask:0xf
    v_cndmask_b32_dpp v108, v96, v104, vcc quad_perm:[1,0,3,2] row_mask:0xf bank_mask:0xf
    s_not_b64 vcc, vcc
    v_cndmask_b32_dpp v100, v104, v96, vcc quad_perm:[1,0,3,2] row_mask:0xf bank_mask:0xf
    v_cndmask_b32_dpp v103, v107, v99, vcc quad_perm:[1,0,3,2] row_mask:0xf bank_mask:0xf
    v_cndmask_b32_dpp v101, v105, v97, vcc quad_perm:[1,0,3,2] row_mask:0xf bank_mask:0xf
    v_cndmask_b32_dpp v102, v106, v98, vcc quad_perm:[1,0,3,2] row_mask:0xf bank_mask:0xf
    buffer_store_dwordx4 v[100:103], v230, s[16:19], s45 offen offset:0 sc0 sc1 nt
    buffer_store_dwordx4 v[108:111], v230, s[16:19], s45 offen offset:256 sc0 sc1 nt
    v_pk_mul_f32 v[118:119], v[118:119], v[10:11] op_sel_hi:[1,0]
    v_cvt_pk_bf16_f32 v112, v112, v113
    v_cvt_pk_bf16_f32 v113, v114, v115
    v_cvt_pk_bf16_f32 v114, v116, v117
    v_cvt_pk_bf16_f32 v115, v118, v119
    s_nop 0
    v_permlane16_swap_b32 v112, v114
    v_permlane16_swap_b32 v113, v115
    buffer_store_dwordx4 v[112:115], v231, s[16:19], s51 offen offset:0 sc0 sc1 nt
L_epi:
L_end:
    s_endpgm
L_fallback:
    s_mov_b64 s[30:31], -1
    s_mov_b32 s10, 0x80000
    s_mov_b32 s48, 0
    v_lshrrev_b32 v15, 4, v0
    v_and_b32 v13, 15, v0
    v_lshlrev_b32 v13, 8, v13
    v_lshl_add_u32 v252, v15, 4, v13
    s_waitcnt vmcnt(0) lgkmcnt(0)
    s_nop 7
    s_nop 7
    v_mov_b32 v224, 0xff800000
    v_mov_b32 v228, 0xff800000
    v_mov_b32 v232, 0xff800000
    v_mov_b32 v236, 0xff800000
    v_mov_b32 v240, 0xff800000
    v_mov_b32 v244, 0xff800000
    v_mov_b32 v248, 0xff800000
L_fbloop:
    buffer_load_dwordx4 a[224:227], v252, s[8:11], s48 offen offset:0
    buffer_load_dwordx4 a[228:231], v252, s[8:11], s48 offen offset:64
    buffer_load_dwordx4 a[232:235], v252, s[8:11], s48 offen offset:128
    buffer_load_dwordx4 a[236:239], v252, s[8:11], s48 offen offset:192
    s_waitcnt vmcnt(0)
    v_mfma_f32_16x16x32_bf16 v[128:131], a[224:227], a[112:115], 0
    v_mfma_f32_16x16x32_bf16 v[128:131], a[228:231], a[116:119], v[128:131]
    v_mfma_f32_16x16x32_bf16 v[128:131], a[232:235], a[120:123], v[128:131]
    v_mfma_f32_16x16x32_bf16 v[128:131], a[236:239], a[124:127], v[128:131]
    v_mfma_f32_16x16x32_bf16 v[132:135], a[224:227], a[128:131], 0
    v_mfma_f32_16x16x32_bf16 v[132:135], a[228:231], a[132:135], v[132:135]
    v_mfma_f32_16x16x32_bf16 v[132:135], a[232:235], a[136:139], v[132:135]
    v_mfma_f32_16x16x32_bf16 v[132:135], a[236:239], a[140:143], v[132:135]
    v_mfma_f32_16x16x32_bf16 v[136:139], a[224:227], a[144:147], 0
    v_mfma_f32_16x16x32_bf16 v[136:139], a[228:231], a[148:151], v[136:139]
    v_mfma_f32_16x16x32_bf16 v[136:139], a[232:235], a[152:155], v[136:139]
    v_mfma_f32_16x16x32_bf16 v[136:139], a[236:239], a[156:159], v[136:139]
    v_mfma_f32_16x16x32_bf16 v[140:143], a[224:227], a[160:163], 0
    v_mfma_f32_16x16x32_bf16 v[140:143], a[228:231], a[164:167], v[140:143]
    v_mfma_f32_16x16x32_bf16 v[140:143], a[232:235], a[168:171], v[140:143]
    v_mfma_f32_16x16x32_bf16 v[140:143], a[236:239], a[172:175], v[140:143]
    v_mfma_f32_16x16x32_bf16 v[144:147], a[224:227], a[176:179], 0
    v_mfma_f32_16x16x32_bf16 v[144:147], a[228:231], a[180:183], v[144:147]
    v_mfma_f32_16x16x32_bf16 v[144:147], a[232:235], a[184:187], v[144:147]
    v_mfma_f32_16x16x32_bf16 v[144:147], a[236:239], a[188:191], v[144:147]
    v_mfma_f32_16x16x32_bf16 v[148:151], a[224:227], a[192:195], 0
    v_mfma_f32_16x16x32_bf16 v[148:151], a[228:231], a[196:199], v[148:151]
    v_mfma_f32_16x16x32_bf16 v[148:151], a[232:235], a[200:203], v[148:151]
    v_mfma_f32_16x16x32_bf16 v[148:151], a[236:239], a[204:207], v[148:151]
    v_mfma_f32_16x16x32_bf16 v[152:155], a[224:227], a[208:211], 0
    v_mfma_f32_16x16x32_bf16 v[152:155], a[228:231], a[212:215], v[152:155]
    v_mfma_f32_16x16x32_bf16 v[152:155], a[232:235], a[216:219], v[152:155]
    v_mfma_f32_16x16x32_bf16 v[152:155], a[236:239], a[220:223], v[152:155]
    s_nop 7
    v_max3_f32 v224, v128, v129, v224
    v_max3_f32 v224, v130, v131, v224
    v_max3_f32 v228, v132, v133, v228
    v_max3_f32 v228, v134, v135, v228
    v_max3_f32 v232, v136, v137, v232
    v_max3_f32 v232, v138, v139, v232
    v_max3_f32 v236, v140, v141, v236
    v_max3_f32 v236, v142, v143, v236
    v_max3_f32 v240, v144, v145, v240
    v_max3_f32 v240, v146, v147, v240
    v_max3_f32 v244, v148, v149, v244
    v_max3_f32 v244, v150, v151, v244
    v_max3_f32 v248, v152, v153, v248
    v_max3_f32 v248, v154, v155, v248
    s_add_u32 s48, s48, 0x1000
    s_cmp_lt_u32 s48, 0x80000
    s_cbranch_scc1 L_fbloop
    v_mov_b32 v225, v224
    v_mov_b32 v229, v228
    v_mov_b32 v233, v232
    v_mov_b32 v237, v236
    v_mov_b32 v241, v240
    v_mov_b32 v245, v244
    v_mov_b32 v249, v248
    v_permlane32_swap_b32 v224, v225
    v_permlane32_swap_b32 v228, v229
    v_permlane32_swap_b32 v232, v233
    v_permlane32_swap_b32 v236, v237
    v_permlane32_swap_b32 v240, v241
    v_permlane32_swap_b32 v244, v245
    v_permlane32_swap_b32 v248, v249
    v_max_f32 v224, v224, v225
    v_max_f32 v228, v228, v229
    v_max_f32 v232, v232, v233
    v_max_f32 v236, v236, v237
    v_max_f32 v240, v240, v241
    v_max_f32 v244, v244, v245
    v_max_f32 v248, v248, v249
    v_mov_b32 v225, v224
    v_mov_b32 v229, v228
    v_mov_b32 v233, v232
    v_mov_b32 v237, v236
    v_mov_b32 v241, v240
    v_mov_b32 v245, v244
    v_mov_b32 v249, v248
    v_permlane16_swap_b32 v224, v225
    v_permlane16_swap_b32 v228, v229
    v_permlane16_swap_b32 v232, v233
    v_permlane16_swap_b32 v236, v237
    v_permlane16_swap_b32 v240, v241
    v_permlane16_swap_b32 v244, v245
    v_permlane16_swap_b32 v248, v249
    v_max_f32 v224, v224, v225
    v_max_f32 v228, v228, v229
    v_max_f32 v232, v232, v233
    v_max_f32 v236, v236, v237
    v_max_f32 v240, v240, v241
    v_max_f32 v244, v244, v245
    v_max_f32 v248, v248, v249
    v_sub_f32 v225, 0, v224
    v_sub_f32 v226, 0, v224
    v_sub_f32 v227, 0, v224
    v_sub_f32 v224, 0, v224
    v_sub_f32 v229, 0, v228
    v_sub_f32 v230, 0, v228
    v_sub_f32 v231, 0, v228
    v_sub_f32 v228, 0, v228
    v_sub_f32 v233, 0, v232
    v_sub_f32 v234, 0, v232
    v_sub_f32 v235, 0, v232
    v_sub_f32 v232, 0, v232
    v_sub_f32 v237, 0, v236
    v_sub_f32 v238, 0, v236
    v_sub_f32 v239, 0, v236
    v_sub_f32 v236, 0, v236
    v_sub_f32 v241, 0, v240
    v_sub_f32 v242, 0, v240
    v_sub_f32 v243, 0, v240
    v_sub_f32 v240, 0, v240
    v_sub_f32 v245, 0, v244
    v_sub_f32 v246, 0, v244
    v_sub_f32 v247, 0, v244
    v_sub_f32 v244, 0, v244
    v_sub_f32 v249, 0, v248
    v_sub_f32 v250, 0, v248
    v_sub_f32 v251, 0, v248
    v_sub_f32 v248, 0, v248
    s_barrier
    s_lshr_b32 s56, s2, 4
    s_lshl_b32 s56, s56, 3
    s_and_b32 s57, s2, 7
    s_add_u32 s56, s56, s57
    s_mul_i32 s56, s56, 1
    s_and_b32 s56, s56, 31
    s_lshl_b32 s56, s56, 14
    s_add_u32 s21, s58, s56
    s_mov_b32 s22, s21
    s_mov_b32 s56, 0
    s_mov_b32 s57, 0
    s_mov_b32 s23, s58
    s_mov_b32 s10, 0x80000
    s_lshl_b32 s51, s29, 10
    s_sub_u32 s24, s58, s51
    s_add_u32 s24, s24, 66560
    s_mov_b32 s14, 0x80000
    s_mov_b32 s20, 30
    v_and_b32 v15, 7, v0
    v_lshlrev_b32 v15, 6, v15
    v_bfe_u32 v13, v0, 3, 1
    v_lshl_add_u32 v15, v13, 11, v15
    v_lshrrev_b32 v13, 1, v0
    v_and_b32 v13, 2, v13
    v_lshrrev_b32 v14, 4, v0
    v_xor_b32 v13, v13, v14
    v_lshl_add_u32 v13, v13, 4, v15
    s_lshl_b32 s51, s29, 13
    v_add_u32 v1, s51, v13
    v_lshrrev_b32 v15, 5, v0
    v_and_b32 v14, 31, v0
    v_lshlrev_b32 v14, 3, v14
    v_lshl_add_u32 v15, v15, 11, v14
    s_add_u32 s51, s51, 65536
    v_add_u32 v2, s51, v15
    v_and_b32 v252, 11, v0
    v_lshrrev_b32 v253, 5, v0
    v_cmp_eq_u32 vcc, v252, v253
    v_mov_b32 v15, 0x3f803f80
    s_nop 0
    v_cndmask_b32 v252, 0, v15, vcc
    v_cndmask_b32 v253, 0, v15, vcc
    v_cndmask_b32 v254, 0, v15, vcc
    v_cndmask_b32 v255, 0, v15, vcc
    v_bfe_u32 v14, v0, 2, 1
    v_mul_u32_u24 v14, 0xaaaa, v14
    v_add_u32 v14, 0x4444, v14
    v_mov_b32 v11, 0
    s_mov_b32 m0, s23
    s_nop 0
    buffer_load_dwordx4 v3, s[8:11], s21 offen offset:0 nt lds
    buffer_load_dwordx4 v3, s[8:11], s21 offen offset:2048 nt lds
    s_add_u32 m0, s23, 896
    s_nop 0
    buffer_load_dwordx4 v3, s[8:11], s21 offen offset:128 nt lds
    buffer_load_dwordx4 v3, s[8:11], s21 offen offset:2176 nt lds
    s_add_u32 s21, s21, 0x4000
    s_add_u32 s56, s56, 0x4000
    s_xor_b32 s23, s23, 0x4000
    s_bitset0_b32 s21, 19
    s_andn2_b32 s10, 0x80000, s56
    s_mov_b32 m0, s23
    s_nop 0
    buffer_load_dwordx4 v3, s[8:11], s21 offen offset:0 nt lds
    buffer_load_dwordx4 v3, s[8:11], s21 offen offset:2048 nt lds
    s_add_u32 m0, s23, 896
    s_nop 0
    buffer_load_dwordx4 v3, s[8:11], s21 offen offset:128 nt lds
    buffer_load_dwordx4 v3, s[8:11], s21 offen offset:2176 nt lds
    s_add_u32 s21, s21, 0x4000
    s_add_u32 s56, s56, 0x4000
    s_xor_b32 s23, s23, 0x8000
    s_bitset0_b32 s21, 19
    s_andn2_b32 s10, 0x80000, s56
    s_mov_b32 m0, s24
    s_nop 0
    buffer_load_dwordx4 v12, s[12:15], s22 offen offset:0 nt lds
    buffer_load_dwordx4 v12, s[12:15], s22 offen offset:2048 nt lds
    s_add_u32 m0, s24, s47
    s_nop 0
    buffer_load_dwordx4 v12, s[12:15], s22 offen offset:128 nt lds
    buffer_load_dwordx4 v12, s[12:15], s22 offen offset:2176 nt lds
    s_add_u32 s22, s22, 0x4000
    s_add_u32 s57, s57, 0x4000
    s_xor_b32 s24, s24, 0x4000
    s_bitset0_b32 s22, 19
    s_andn2_b32 s14, 0x80000, s57
    s_mov_b32 m0, s24
    s_nop 0
    buffer_load_dwordx4 v12, s[12:15], s22 offen offset:0 nt lds
    buffer_load_dwordx4 v12, s[12:15], s22 offen offset:2048 nt lds
    s_add_u32 m0, s24, s47
    s_nop 0
    buffer_load_dwordx4 v12, s[12:15], s22 offen offset:128 nt lds
    buffer_load_dwordx4 v12, s[12:15], s22 offen offset:2176 nt lds
    s_add_u32 s22, s22, 0x4000
    s_add_u32 s57, s57, 0x4000
    s_xor_b32 s24, s24, 0x8000
    s_bitset0_b32 s22, 19
    s_andn2_b32 s14, 0x80000, s57
    s_mov_b32 m0, s23
    s_nop 0
    buffer_load_dwordx4 v3, s[8:11], s21 offen offset:0 nt lds
    buffer_load_dwordx4 v3, s[8:11], s21 offen offset:2048 nt lds
    s_add_u32 m0, s23, 896
    s_nop 0
    buffer_load_dwordx4 v3, s[8:11], s21 offen offset:128 nt lds
    buffer_load_dwordx4 v3, s[8:11], s21 offen offset:2176 nt lds
    s_add_u32 s21, s21, 0x4000
    s_add_u32 s56, s56, 0x4000
    s_xor_b32 s23, s23, 0x4000
    s_bitset0_b32 s21, 19
    s_andn2_b32 s10, 0x80000, s56
    v_accvgpr_write_b32 a0, 0
    v_accvgpr_write_b32 a1, 0
    v_accvgpr_write_b32 a2, 0
    v_accvgpr_write_b32 a3, 0
    v_accvgpr_write_b32 a4, 0
    v_accvgpr_write_b32 a5, 0
    v_accvgpr_write_b32 a6, 0
    v_accvgpr_write_b32 a7, 0
    v_accvgpr_write_b32 a8, 0
    v_accvgpr_write_b32 a9, 0
    v_accvgpr_write_b32 a10, 0
    v_accvgpr_write_b32 a11, 0
    v_accvgpr_write_b32 a12, 0
    v_accvgpr_write_b32 a13, 0
    v_accvgpr_write_b32 a14, 0
    v_accvgpr_write_b32 a15, 0
    v_accvgpr_write_b32 a16, 0
    v_accvgpr_write_b32 a17, 0
    v_accvgpr_write_b32 a18, 0
    v_accvgpr_write_b32 a19, 0
    v_accvgpr_write_b32 a20, 0
    v_accvgpr_write_b32 a21, 0
    v_accvgpr_write_b32 a22, 0
    v_accvgpr_write_b32 a23, 0
    v_accvgpr_write_b32 a24, 0
    v_accvgpr_write_b32 a25, 0
    v_accvgpr_write_b32 a26, 0
    v_accvgpr_write_b32 a27, 0
    v_accvgpr_write_b32 a28, 0
    v_accvgpr_write_b32 a29, 0
    v_accvgpr_write_b32 a30, 0
    v_accvgpr_write_b32 a31, 0
    v_accvgpr_write_b32 a32, 0
    v_accvgpr_write_b32 a33, 0
    v_accvgpr_write_b32 a34, 0
    v_accvgpr_write_b32 a35, 0
    v_accvgpr_write_b32 a36, 0
    v_accvgpr_write_b32 a37, 0
    v_accvgpr_write_b32 a38, 0
    v_accvgpr_write_b32 a39, 0
    v_accvgpr_write_b32 a40, 0
    v_accvgpr_write_b32 a41, 0
    v_accvgpr_write_b32 a42, 0
    v_accvgpr_write_b32 a43, 0
    v_accvgpr_write_b32 a44, 0
    v_accvgpr_write_b32 a45, 0
    v_accvgpr_write_b32 a46, 0
    v_accvgpr_write_b32 a47, 0
    v_accvgpr_write_b32 a48, 0
    v_accvgpr_write_b32 a49, 0
    v_accvgpr_write_b32 a50, 0
    v_accvgpr_write_b32 a51, 0
    v_accvgpr_write_b32 a52, 0
    v_accvgpr_write_b32 a53, 0
    v_accvgpr_write_b32 a54, 0
    v_accvgpr_write_b32 a55, 0
    v_accvgpr_write_b32 a56, 0
    v_accvgpr_write_b32 a57, 0
    v_accvgpr_write_b32 a58, 0
    v_accvgpr_write_b32 a59, 0
    v_accvgpr_write_b32 a60, 0
    v_accvgpr_write_b32 a61, 0
    v_accvgpr_write_b32 a62, 0
    v_accvgpr_write_b32 a63, 0
    v_accvgpr_write_b32 a64, 0
    v_accvgpr_write_b32 a65, 0
    v_accvgpr_write_b32 a66, 0
    v_accvgpr_write_b32 a67, 0
    v_accvgpr_write_b32 a68, 0
    v_accvgpr_write_b32 a69, 0
    v_accvgpr_write_b32 a70, 0
    v_accvgpr_write_b32 a71, 0
    v_accvgpr_write_b32 a72, 0
    v_accvgpr_write_b32 a73, 0
    v_accvgpr_write_b32 a74, 0
    v_accvgpr_write_b32 a75, 0
    v_accvgpr_write_b32 a76, 0
    v_accvgpr_write_b32 a77, 0
    v_accvgpr_write_b32 a78, 0
    v_accvgpr_write_b32 a79, 0
    v_accvgpr_write_b32 a80, 0
    v_accvgpr_write_b32 a81, 0
    v_accvgpr_write_b32 a82, 0
    v_accvgpr_write_b32 a83, 0
    v_accvgpr_write_b32 a84, 0
    v_accvgpr_write_b32 a85, 0
    v_accvgpr_write_b32 a86, 0
    v_accvgpr_write_b32 a87, 0
    v_accvgpr_write_b32 a88, 0
    v_accvgpr_write_b32 a89, 0
    v_accvgpr_write_b32 a90, 0
    v_accvgpr_write_b32 a91, 0
    v_accvgpr_write_b32 a92, 0
    v_accvgpr_write_b32 a93, 0
    v_accvgpr_write_b32 a94, 0
    v_accvgpr_write_b32 a95, 0
    v_accvgpr_write_b32 a96, 0
    v_accvgpr_write_b32 a97, 0
    v_accvgpr_write_b32 a98, 0
    v_accvgpr_write_b32 a99, 0
    v_accvgpr_write_b32 a100, 0
    v_accvgpr_write_b32 a101, 0
    v_accvgpr_write_b32 a102, 0
    v_accvgpr_write_b32 a103, 0
    v_accvgpr_write_b32 a104, 0
    v_accvgpr_write_b32 a105, 0
    v_accvgpr_write_b32 a106, 0
    v_accvgpr_write_b32 a107, 0
    v_accvgpr_write_b32 a108, 0
    v_accvgpr_write_b32 a109, 0
    v_accvgpr_write_b32 a110, 0
    v_accvgpr_write_b32 a111, 0
    v_mov_b32 v16, 0
    v_mov_b32 v17, 0
    v_mov_b32 v18, 0
    v_mov_b32 v19, 0
    v_mov_b32 v20, 0
    v_mov_b32 v21, 0
    v_mov_b32 v22, 0
    v_mov_b32 v23, 0
    v_mov_b32 v24, 0
    v_mov_b32 v25, 0
    v_mov_b32 v26, 0
    v_mov_b32 v27, 0
    v_mov_b32 v28, 0
    v_mov_b32 v29, 0
    v_mov_b32 v30, 0
    v_mov_b32 v31, 0
    v_mov_b32 v32, 0
    v_mov_b32 v33, 0
    v_mov_b32 v34, 0
    v_mov_b32 v35, 0
    v_mov_b32 v36, 0
    v_mov_b32 v37, 0
    v_mov_b32 v38, 0
    v_mov_b32 v39, 0
    v_mov_b32 v40, 0
    v_mov_b32 v41, 0
    v_mov_b32 v42, 0
    v_mov_b32 v43, 0
    v_mov_b32 v44, 0
    v_mov_b32 v45, 0
    v_mov_b32 v46, 0
    v_mov_b32 v47, 0
    v_mov_b32 v48, 0
    v_mov_b32 v49, 0
    v_mov_b32 v50, 0
    v_mov_b32 v51, 0
    v_mov_b32 v52, 0
    v_mov_b32 v53, 0
    v_mov_b32 v54, 0
    v_mov_b32 v55, 0
    v_mov_b32 v56, 0
    v_mov_b32 v57, 0
    v_mov_b32 v58, 0
    v_mov_b32 v59, 0
    v_mov_b32 v60, 0
    v_mov_b32 v61, 0
    v_mov_b32 v62, 0
    v_mov_b32 v63, 0
    v_mov_b32 v64, 0
    v_mov_b32 v65, 0
    v_mov_b32 v66, 0
    v_mov_b32 v67, 0
    v_mov_b32 v68, 0
    v_mov_b32 v69, 0
    v_mov_b32 v70, 0
    v_mov_b32 v71, 0
    v_mov_b32 v72, 0
    v_mov_b32 v73, 0
    v_mov_b32 v74, 0
    v_mov_b32 v75, 0
    v_mov_b32 v76, 0
    v_mov_b32 v77, 0
    v_mov_b32 v78, 0
    v_mov_b32 v79, 0
    v_mov_b32 v80, 0
    v_mov_b32 v81, 0
    v_mov_b32 v82, 0
    v_mov_b32 v83, 0
    v_mov_b32 v84, 0
    v_mov_b32 v85, 0
    v_mov_b32 v86, 0
    v_mov_b32 v87, 0
    v_mov_b32 v88, 0
    v_mov_b32 v89, 0
    v_mov_b32 v90, 0
    v_mov_b32 v91, 0
    v_mov_b32 v92, 0
    v_mov_b32 v93, 0
    v_mov_b32 v94, 0
    v_mov_b32 v95, 0
    v_mov_b32 v96, 0
    v_mov_b32 v97, 0
    v_mov_b32 v98, 0
    v_mov_b32 v99, 0
    v_mov_b32 v100, 0
    v_mov_b32 v101, 0
    v_mov_b32 v102, 0
    v_mov_b32 v103, 0
    v_mov_b32 v104, 0
    v_mov_b32 v105, 0
    v_mov_b32 v106, 0
    v_mov_b32 v107, 0
    v_mov_b32 v108, 0
    v_mov_b32 v109, 0
    v_mov_b32 v110, 0
    v_mov_b32 v111, 0
    v_mov_b32 v112, 0
    v_mov_b32 v113, 0
    v_mov_b32 v114, 0
    v_mov_b32 v115, 0
    v_mov_b32 v116, 0
    v_mov_b32 v117, 0
    v_mov_b32 v118, 0
    v_mov_b32 v119, 0
    v_mov_b32 v120, 0
    v_mov_b32 v121, 0
    v_mov_b32 v122, 0
    v_mov_b32 v123, 0
    v_mov_b32 v124, 0
    v_mov_b32 v125, 0
    v_mov_b32 v126, 0
    v_mov_b32 v127, 0
    v_mov_b32 v4, 0
    v_mov_b32 v5, 0
    v_mov_b32 v6, 0
    v_mov_b32 v7, 0
    v_mov_b32 v8, 0
    v_mov_b32 v9, 0
    v_mov_b32 v10, 0
    s_waitcnt vmcnt(16)
    s_barrier
    ds_read_b128 a[224:227], v1 offset:0
    ds_read_b128 a[228:231], v1 offset:512
    ds_read_b128 a[232:235], v1 offset:1024
    ds_read_b128 a[236:239], v1 offset:1536
    ds_read_b128 a[240:243], v1 offset:4096
    ds_read_b128 a[244:247], v1 offset:4608
    ds_read_b128 a[248:251], v1 offset:5120
    ds_read_b128 a[252:255], v1 offset:5632
    s_waitcnt lgkmcnt(0)
    v_mfma_f32_16x16x32_bf16 v[128:131], a[224:227], a[112:115], v[224:227]
    v_mfma_f32_16x16x32_bf16 v[156:159], a[240:243], a[112:115], v[224:227]
    v_mfma_f32_16x16x32_bf16 v[128:131], a[228:231], a[116:119], v[128:131]
    v_mfma_f32_16x16x32_bf16 v[156:159], a[244:247], a[116:119], v[156:159]
    v_mfma_f32_16x16x32_bf16 v[128:131], a[232:235], a[120:123], v[128:131]
    v_mfma_f32_16x16x32_bf16 v[156:159], a[248:251], a[120:123], v[156:159]
    v_mfma_f32_16x16x32_bf16 v[128:131], a[236:239], a[124:127], v[128:131]
    v_mfma_f32_16x16x32_bf16 v[156:159], a[252:255], a[124:127], v[156:159]
    v_mfma_f32_16x16x32_bf16 v[132:135], a[224:227], a[128:131], v[228:231]
    v_mfma_f32_16x16x32_bf16 v[160:163], a[240:243], a[128:131], v[228:231]
    v_mfma_f32_16x16x32_bf16 v[132:135], a[228:231], a[132:135], v[132:135]
    v_mfma_f32_16x16x32_bf16 v[160:163], a[244:247], a[132:135], v[160:163]
    v_mfma_f32_16x16x32_bf16 v[132:135], a[232:235], a[136:139], v[132:135]
    v_mfma_f32_16x16x32_bf16 v[160:163], a[248:251], a[136:139], v[160:163]
    v_mfma_f32_16x16x32_bf16 v[132:135], a[236:239], a[140:143], v[132:135]
    v_mfma_f32_16x16x32_bf16 v[160:163], a[252:255], a[140:143], v[160:163]
    v_mfma_f32_16x16x32_bf16 v[136:139], a[224:227], a[144:147], v[232:235]
    v_mfma_f32_16x16x32_bf16 v[164:167], a[240:243], a[144:147], v[232:235]
    v_mfma_f32_16x16x32_bf16 v[136:139], a[228:231], a[148:151], v[136:139]
    v_mfma_f32_16x16x32_bf16 v[164:167], a[244:247], a[148:151], v[164:167]
    v_mfma_f32_16x16x32_bf16 v[136:139], a[232:235], a[152:155], v[136:139]
    v_mfma_f32_16x16x32_bf16 v[164:167], a[248:251], a[152:155], v[164:167]
    v_mfma_f32_16x16x32_bf16 v[136:139], a[236:239], a[156:159], v[136:139]
    v_mfma_f32_16x16x32_bf16 v[164:167], a[252:255], a[156:159], v[164:167]
    v_mfma_f32_16x16x32_bf16 v[140:143], a[224:227], a[160:163], v[236:239]
    v_mfma_f32_16x16x32_bf16 v[168:171], a[240:243], a[160:163], v[236:239]
    v_mfma_f32_16x16x32_bf16 v[140:143], a[228:231], a[164:167], v[140:143]
    v_mfma_f32_16x16x32_bf16 v[168:171], a[244:247], a[164:167], v[168:171]
    v_mfma_f32_16x16x32_bf16 v[140:143], a[232:235], a[168:171], v[140:143]
    v_mfma_f32_16x16x32_bf16 v[168:171], a[248:251], a[168:171], v[168:171]
    v_mfma_f32_16x16x32_bf16 v[140:143], a[236:239], a[172:175], v[140:143]
    v_mfma_f32_16x16x32_bf16 v[168:171], a[252:255], a[172:175], v[168:171]
    v_mfma_f32_16x16x32_bf16 v[144:147], a[224:227], a[176:179], v[240:243]
    v_mfma_f32_16x16x32_bf16 v[172:175], a[240:243], a[176:179], v[240:243]
    v_mfma_f32_16x16x32_bf16 v[144:147], a[228:231], a[180:183], v[144:147]
    v_mfma_f32_16x16x32_bf16 v[172:175], a[244:247], a[180:183], v[172:175]
    v_mfma_f32_16x16x32_bf16 v[144:147], a[232:235], a[184:187], v[144:147]
    v_mfma_f32_16x16x32_bf16 v[172:175], a[248:251], a[184:187], v[172:175]
    v_mfma_f32_16x16x32_bf16 v[144:147], a[236:239], a[188:191], v[144:147]
    v_mfma_f32_16x16x32_bf16 v[172:175], a[252:255], a[188:191], v[172:175]
    v_mfma_f32_16x16x32_bf16 v[148:151], a[224:227], a[192:195], v[244:247]
    v_mfma_f32_16x16x32_bf16 v[176:179], a[240:243], a[192:195], v[244:247]
    v_mfma_f32_16x16x32_bf16 v[148:151], a[228:231], a[196:199], v[148:151]
    v_mfma_f32_16x16x32_bf16 v[176:179], a[244:247], a[196:199], v[176:179]
    v_mfma_f32_16x16x32_bf16 v[148:151], a[232:235], a[200:203], v[148:151]
    v_mfma_f32_16x16x32_bf16 v[176:179], a[248:251], a[200:203], v[176:179]
    v_mfma_f32_16x16x32_bf16 v[148:151], a[236:239], a[204:207], v[148:151]
    v_mfma_f32_16x16x32_bf16 v[176:179], a[252:255], a[204:207], v[176:179]
    v_mfma_f32_16x16x32_bf16 v[152:155], a[224:227], a[208:211], v[248:251]
    v_mfma_f32_16x16x32_bf16 v[180:183], a[240:243], a[208:211], v[248:251]
    v_mfma_f32_16x16x32_bf16 v[152:155], a[228:231], a[212:215], v[152:155]
    v_mfma_f32_16x16x32_bf16 v[180:183], a[244:247], a[212:215], v[180:183]
    v_mfma_f32_16x16x32_bf16 v[152:155], a[232:235], a[216:219], v[152:155]
    v_mfma_f32_16x16x32_bf16 v[180:183], a[248:251], a[216:219], v[180:183]
    v_mfma_f32_16x16x32_bf16 v[152:155], a[236:239], a[220:223], v[152:155]
    v_mfma_f32_16x16x32_bf16 v[180:183], a[252:255], a[220:223], v[180:183]
    s_nop 7
    v_exp_f32 v128, v128
    v_exp_f32 v129, v129
    v_exp_f32 v130, v130
    v_exp_f32 v131, v131
    v_exp_f32 v156, v156
    v_exp_f32 v157, v157
    v_exp_f32 v158, v158
    v_exp_f32 v159, v159
    v_fmac_f32 v4, s100, v129
    v_fmac_f32 v4, s100, v130
    v_fmac_f32 v4, s100, v131
    v_fmac_f32 v4, s100, v128
    v_fmac_f32 v4, s100, v156
    v_fmac_f32 v4, s100, v157
    v_fmac_f32 v4, s100, v158
    v_fmac_f32 v4, s100, v159
    v_exp_f32 v132, v132
    v_exp_f32 v133, v133
    v_exp_f32 v134, v134
    v_exp_f32 v135, v135
    v_exp_f32 v160, v160
    v_exp_f32 v161, v161
    v_exp_f32 v162, v162
    v_exp_f32 v163, v163
    v_add_f32 v5, v132, v5
    v_add_f32 v5, v133, v5
    v_add_f32 v5, v134, v5
    v_add_f32 v5, v135, v5
    v_fmac_f32 v5, s100, v160
    v_fmac_f32 v5, s100, v161
    v_fmac_f32 v5, s100, v162
    v_fmac_f32 v5, s100, v163
    v_exp_f32 v136, v136
    v_exp_f32 v137, v137
    v_exp_f32 v138, v138
    v_exp_f32 v139, v139
    v_exp_f32 v164, v164
    v_exp_f32 v165, v165
    v_exp_f32 v166, v166
    v_exp_f32 v167, v167
    v_fmac_f32 v6, s100, v136
    v_fmac_f32 v6, s100, v137
    v_fmac_f32 v6, s100, v138
    v_fmac_f32 v6, s100, v139
    v_fmac_f32 v6, s100, v164
    v_fmac_f32 v6, s100, v165
    v_fmac_f32 v6, s100, v166
    v_fmac_f32 v6, s100, v167
    v_exp_f32 v140, v140
    v_exp_f32 v141, v141
    v_exp_f32 v142, v142
    v_exp_f32 v143, v143
    v_exp_f32 v168, v168
    v_exp_f32 v169, v169
    v_exp_f32 v170, v170
    v_exp_f32 v171, v171
    v_add_f32 v7, v140, v7
    v_add_f32 v7, v141, v7
    v_add_f32 v7, v142, v7
    v_add_f32 v7, v143, v7
    v_fmac_f32 v7, s100, v168
    v_exp_f32 v144, v144
    v_exp_f32 v145, v145
    v_exp_f32 v146, v146
    v_exp_f32 v147, v147
    v_exp_f32 v172, v172
    v_exp_f32 v173, v173
    v_exp_f32 v174, v174
    v_exp_f32 v175, v175
    v_fmac_f32 v8, s100, v144
    v_fmac_f32 v8, s100, v145
    v_fmac_f32 v8, s100, v146
    v_fmac_f32 v8, s100, v147
    v_exp_f32 v148, v148
    v_exp_f32 v149, v149
    v_exp_f32 v150, v150
    v_exp_f32 v151, v151
    v_exp_f32 v176, v176
    v_add_f32 v9, v148, v9
    v_add_f32 v9, v149, v9
    v_add_f32 v9, v150, v9
    v_add_f32 v9, v151, v9
    s_branch L_join
.p2align 6
L_Af:
    s_waitcnt lgkmcnt(3)
    v_mfma_f32_16x16x32_bf16 v[128:131], a[224:227], a[112:115], v[224:227]
    s_waitcnt lgkmcnt(2)
    v_exp_f32 v178, v178
    v_mfma_f32_16x16x32_bf16 v[128:131], a[228:231], a[116:119], v[128:131]
    s_waitcnt lgkmcnt(1)
    ds_read_b64_tr_b16 a[242:243], v2 offset:0
    v_cvt_pk_bf16_f32 v193, v162, v163
    v_mfma_f32_16x16x32_bf16 v[128:131], a[232:235], a[120:123], v[128:131]
    s_waitcnt lgkmcnt(1)
    v_exp_f32 v179, v179
    v_mfma_f32_16x16x32_bf16 v[128:131], a[236:239], a[124:127], v[128:131]
    s_add_u32 s21, s21, 0x4000
    ds_read_b64_tr_b16 a[240:241], v2 offset:4096
    v_cvt_pk_bf16_f32 v198, v164, v165
    v_mfma_f32_16x16x32_bf16 v[132:135], a[236:239], a[140:143], v[228:231]
    s_add_u32 s56, s56, 0x4000
    v_exp_f32 v180, v180
    v_mfma_f32_16x16x32_bf16 v[132:135], a[232:235], a[136:139], v[132:135]
    s_xor_b32 s23, s23, s26
    ds_read_b64_tr_b16 a[246:247], v2 offset:256
    v_cvt_pk_bf16_f32 v187, v158, v159
    v_mfma_f32_16x16x32_bf16 v[132:135], a[228:231], a[132:135], v[132:135]
    s_bitset0_b32 s21, 19
    v_exp_f32 v181, v181
    v_mfma_f32_16x16x32_bf16 v[132:135], a[224:227], a[128:131], v[132:135]
    s_andn2_b32 s10, 0x80000, s56
    v_exp_f32 v182, v182
    v_mfma_f32_16x16x32_bf16 v[136:139], a[224:227], a[144:147], v[232:235]
    ds_read_b64_tr_b16 a[244:245], v2 offset:4352
    v_cvt_pk_bf16_f32 v192, v160, v161
    v_mfma_f32_16x16x32_bf16 v[136:139], a[228:231], a[148:151], v[136:139]
    v_exp_f32 v183, v183
    v_mfma_f32_16x16x32_bf16 v[136:139], a[232:235], a[152:155], v[136:139]
    ds_read_b64_tr_b16 a[250:251], v2 offset:512
    v_cvt_pk_bf16_f32 v221, v182, v183
    v_mfma_f32_16x16x32_bf16 v[136:139], a[236:239], a[156:159], v[136:139]
    v_exp_f32 v128, v128
    v_mfma_f32_16x16x32_bf16 v[140:143], a[236:239], a[172:175], v[236:239]
    v_cvt_pk_bf16_f32 v199, v166, v167
    v_cvt_pk_bf16_f32 v220, v180, v181
    v_mfma_f32_16x16x32_bf16 v[140:143], a[232:235], a[168:171], v[140:143]
    ds_read_b64_tr_b16 a[248:249], v2 offset:4608
    v_cvt_pk_bf16_f32 v204, v168, v169
    v_mfma_f32_16x16x32_bf16 v[140:143], a[228:231], a[164:167], v[140:143]
    v_exp_f32 v129, v129
    v_mfma_f32_16x16x32_bf16 v[140:143], a[224:227], a[160:163], v[140:143]
    ds_read_b64_tr_b16 a[254:255], v2 offset:768
    v_cvt_pk_bf16_f32 v205, v170, v171
    v_mfma_f32_16x16x32_bf16 v[144:147], a[224:227], a[176:179], v[240:243]
    v_exp_f32 v130, v130
    v_mfma_f32_16x16x32_bf16 v[144:147], a[228:231], a[180:183], v[144:147]
    ds_read_b64_tr_b16 a[252:253], v2 offset:4864
    v_add_f32 v4, v129, v4
    v_mfma_f32_16x16x32_bf16 v[144:147], a[232:235], a[184:187], v[144:147]
    v_exp_f32 v131, v131
    v_mfma_f32_16x16x32_bf16 v[144:147], a[236:239], a[188:191], v[144:147]
    v_exp_f32 v132, v132
    v_mfma_f32_16x16x32_bf16 v[148:151], a[236:239], a[204:207], v[244:247]
    v_add_f32 v4, v130, v4
    v_cvt_pk_bf16_f32 v185, v130, v131
    v_mfma_f32_16x16x32_bf16 v[148:151], a[232:235], a[200:203], v[148:151]
    v_exp_f32 v133, v133
    v_mfma_f32_16x16x32_bf16 v[148:151], a[228:231], a[196:199], v[148:151]
    v_cvt_pk_bf16_f32 v190, v132, v133
    v_add_f32 v4, v131, v4
    v_mfma_f32_16x16x32_bf16 v[148:151], a[224:227], a[192:195], v[148:151]
    s_waitcnt lgkmcnt(6)
    v_exp_f32 v134, v134
    v_mfma_f32_16x16x32_bf16 a[0:3], a[240:243], v[186:189], a[0:3]
    s_waitcnt lgkmcnt(4)
    v_cvt_pk_bf16_f32 v210, v172, v173
    v_cvt_pk_bf16_f32 v211, v174, v175
    v_mfma_f32_16x16x32_bf16 a[4:7], a[244:247], v[186:189], a[4:7]
    s_mov_b32 m0, s24
    v_exp_f32 v135, v135
    v_mfma_f32_16x16x32_bf16 a[16:19], a[240:243], v[192:195], a[16:19]
    buffer_load_dwordx4 v12, s[12:15], s22 offen offset:0 nt lds
    v_mfma_f32_16x16x32_bf16 a[20:23], a[244:247], v[192:195], a[20:23]
    v_cvt_pk_bf16_f32 v191, v134, v135
    v_cvt_pk_bf16_f32 v216, v176, v177
    v_mfma_f32_16x16x32_bf16 a[32:35], a[240:243], v[198:201], a[32:35]
    ds_read_b128 a[224:227], v1 offset:4096
    v_cvt_pk_bf16_f32 v217, v178, v179
    v_mfma_f32_16x16x32_bf16 a[36:39], a[244:247], v[198:201], a[36:39]
    v_exp_f32 v136, v136
    v_mfma_f32_16x16x32_bf16 a[48:51], a[240:243], v[204:207], a[48:51]
    v_exp_f32 v137, v137
    v_mfma_f32_16x16x32_bf16 a[52:55], a[244:247], v[204:207], a[52:55]
    v_add_f32 v6, v136, v6
    v_cvt_pk_bf16_f32 v196, v136, v137
    v_mfma_f32_16x16x32_bf16 a[64:67], a[240:243], v[210:213], a[64:67]
    ds_read_b128 a[228:231], v1 offset:4608
    v_add_f32 v6, v137, v6
    v_mfma_f32_16x16x32_bf16 a[68:71], a[244:247], v[210:213], a[68:71]
    buffer_load_dwordx4 v12, s[12:15], s22 offen offset:2048 nt lds
    v_mfma_f32_16x16x32_bf16 a[80:83], a[240:243], v[216:219], a[80:83]
    v_exp_f32 v138, v138
    v_mfma_f32_16x16x32_bf16 a[84:87], a[244:247], v[216:219], a[84:87]
    v_exp_f32 v139, v139
    v_mfma_f32_16x16x32_bf16 a[96:99], a[240:243], v[220:223], a[96:99]
    v_exp_f32 v140, v140
    v_mfma_f32_16x16x32_bf16 a[100:103], a[244:247], v[220:223], a[100:103]
    s_waitcnt lgkmcnt(4)
    v_add_f32 v6, v138, v6
    v_cvt_pk_bf16_f32 v197, v138, v139
    v_mfma_f32_16x16x32_bf16 a[104:107], a[248:251], v[220:223], a[104:107]
    s_waitcnt lgkmcnt(2)
    ds_read_b128 a[232:235], v1 offset:5120
    v_add_f32 v6, v139, v6
    v_mfma_f32_16x16x32_bf16 a[108:111], a[252:255], v[220:223], a[108:111]
    s_add_u32 m0, s24, s47
    v_exp_f32 v141, v141
    v_mfma_f32_16x16x32_bf16 a[88:91], a[248:251], v[216:219], a[88:91]
    buffer_load_dwordx4 v12, s[12:15], s22 offen offset:128 nt lds
    v_mfma_f32_16x16x32_bf16 a[92:95], a[252:255], v[216:219], a[92:95]
    v_exp_f32 v142, v142
    v_mfma_f32_16x16x32_bf16 a[72:75], a[248:251], v[210:213], a[72:75]
    v_exp_f32 v143, v143
    v_mfma_f32_16x16x32_bf16 a[76:79], a[252:255], v[210:213], a[76:79]
    ds_read_b128 a[236:239], v1 offset:5632
    v_cvt_pk_bf16_f32 v202, v140, v141
    v_mfma_f32_16x16x32_bf16 a[56:59], a[248:251], v[204:207], a[56:59]
    v_cvt_pk_bf16_f32 v203, v142, v143
    v_xor_b32 v1, s26, v1
    v_smfmac_f32_16x16x64_bf16 v[4:7], v[252:255], v[186:193], v14
    v_exp_f32 v144, v144
    v_mfma_f32_16x16x32_bf16 a[60:63], a[252:255], v[204:207], a[60:63]
    buffer_load_dwordx4 v12, s[12:15], s22 offen offset:2176 nt lds
    v_mfma_f32_16x16x32_bf16 a[40:43], a[248:251], v[198:201], a[40:43]
    s_add_u32 s22, s22, 0x4000
    v_exp_f32 v145, v145
    v_mfma_f32_16x16x32_bf16 a[44:47], a[252:255], v[198:201], a[44:47]
    s_add_u32 s57, s57, 0x4000
    v_add_f32 v8, v144, v8
    v_cvt_pk_bf16_f32 v208, v144, v145
    v_mfma_f32_16x16x32_bf16 a[24:27], a[248:251], v[192:195], a[24:27]
    s_xor_b32 s24, s24, s26
    v_exp_f32 v146, v146
    v_mfma_f32_16x16x32_bf16 a[28:31], a[252:255], v[192:195], a[28:31]
    s_bitset0_b32 s22, 19
    v_add_f32 v8, v145, v8
    v_add_f32 v8, v146, v8
    v_mfma_f32_16x16x32_bf16 a[8:11], a[248:251], v[186:189], a[8:11]
    s_andn2_b32 s14, 0x80000, s57
    v_exp_f32 v147, v147
    v_mfma_f32_16x16x32_bf16 a[12:15], a[252:255], v[186:189], a[12:15]
    s_waitcnt lgkmcnt(3)
    v_cvt_pk_bf16_f32 v209, v146, v147
    v_add_f32 v8, v147, v8
    v_mfma_f32_16x16x32_bf16 v[156:159], a[224:227], a[112:115], v[224:227]
    s_waitcnt lgkmcnt(2)
    v_exp_f32 v148, v148
    v_mfma_f32_16x16x32_bf16 v[156:159], a[228:231], a[116:119], v[156:159]
    s_waitcnt lgkmcnt(1)
    ds_read_b64_tr_b16 a[242:243], v2 offset:1024
    v_add_f32 v4, v128, v4
    v_mfma_f32_16x16x32_bf16 v[156:159], a[232:235], a[120:123], v[156:159]
    s_waitcnt lgkmcnt(1)
    v_exp_f32 v149, v149
    v_mfma_f32_16x16x32_bf16 v[156:159], a[236:239], a[124:127], v[156:159]
    ds_read_b64_tr_b16 a[240:241], v2 offset:5120
    v_cvt_pk_bf16_f32 v214, v148, v149
    v_mfma_f32_16x16x32_bf16 v[160:163], a[236:239], a[140:143], v[228:231]
    v_exp_f32 v150, v150
    v_mfma_f32_16x16x32_bf16 v[160:163], a[232:235], a[136:139], v[160:163]
    ds_read_b64_tr_b16 a[246:247], v2 offset:1280
    v_cvt_pk_bf16_f32 v184, v128, v129
    v_mfma_f32_16x16x32_bf16 v[160:163], a[228:231], a[132:135], v[160:163]
    v_exp_f32 v151, v151
    v_mfma_f32_16x16x32_bf16 v[160:163], a[224:227], a[128:131], v[160:163]
    v_cvt_pk_bf16_f32 v215, v150, v151
    v_add_f32 v10, v180, v10
    v_mfma_f32_16x16x32_bf16 v[164:167], a[224:227], a[144:147], v[232:235]
    ds_read_b64_tr_b16 a[244:245], v2 offset:5376
    v_add_f32 v10, v181, v10
    v_mfma_f32_16x16x32_bf16 v[164:167], a[228:231], a[148:151], v[164:167]
    v_exp_f32 v156, v156
    v_mfma_f32_16x16x32_bf16 v[164:167], a[232:235], a[152:155], v[164:167]
    ds_read_b64_tr_b16 a[250:251], v2 offset:1536
    v_add_f32 v4, v156, v4
    v_mfma_f32_16x16x32_bf16 v[164:167], a[236:239], a[156:159], v[164:167]
    v_exp_f32 v157, v157
    v_mfma_f32_16x16x32_bf16 v[168:171], a[236:239], a[172:175], v[236:239]
    v_add_f32 v4, v157, v4
    v_add_f32 v10, v182, v10
    v_mfma_f32_16x16x32_bf16 v[168:171], a[232:235], a[168:171], v[168:171]
    ds_read_b64_tr_b16 a[248:249], v2 offset:5632
    v_add_f32 v10, v183, v10
    v_mfma_f32_16x16x32_bf16 v[168:171], a[228:231], a[164:167], v[168:171]
    v_exp_f32 v158, v158
    v_mfma_f32_16x16x32_bf16 v[168:171], a[224:227], a[160:163], v[168:171]
    ds_read_b64_tr_b16 a[254:255], v2 offset:1792
    v_add_f32 v4, v158, v4
    v_mfma_f32_16x16x32_bf16 v[172:175], a[224:227], a[176:179], v[240:243]
    v_exp_f32 v159, v159
    v_mfma_f32_16x16x32_bf16 v[172:175], a[228:231], a[180:183], v[172:175]
    ds_read_b64_tr_b16 a[252:253], v2 offset:5888
    v_add_f32 v4, v159, v4
    v_mfma_f32_16x16x32_bf16 v[172:175], a[232:235], a[184:187], v[172:175]
    v_exp_f32 v160, v160
    v_mfma_f32_16x16x32_bf16 v[172:175], a[236:239], a[188:191], v[172:175]
    v_exp_f32 v161, v161
    v_mfma_f32_16x16x32_bf16 v[176:179], a[236:239], a[204:207], v[244:247]
    v_xor_b32 v2, s25, v2
    v_add_f32 v5, v160, v5
    v_mfma_f32_16x16x32_bf16 v[176:179], a[232:235], a[200:203], v[176:179]
    v_exp_f32 v162, v162
    v_mfma_f32_16x16x32_bf16 v[176:179], a[228:231], a[196:199], v[176:179]
    v_add_f32 v5, v161, v5
    v_add_f32 v5, v162, v5
    v_mfma_f32_16x16x32_bf16 v[176:179], a[224:227], a[192:195], v[176:179]
    v_exp_f32 v163, v163
    v_smfmac_f32_16x16x64_bf16 v[6:9], v[252:255], v[198:205], v14
    s_waitcnt lgkmcnt(6)
    v_add_f32 v5, v163, v5
    v_mfma_f32_16x16x32_bf16 v[112:115], a[240:243], v[220:223], v[112:115]
    s_waitcnt lgkmcnt(4)
    v_mfma_f32_16x16x32_bf16 v[116:119], a[244:247], v[220:223], v[116:119]
    v_exp_f32 v164, v164
    v_mfma_f32_16x16x32_bf16 v[96:99], a[240:243], v[216:219], v[96:99]
    v_mfma_f32_16x16x32_bf16 v[100:103], a[244:247], v[216:219], v[100:103]
    v_exp_f32 v165, v165
    v_mfma_f32_16x16x32_bf16 v[80:83], a[240:243], v[210:213], v[80:83]
    v_add_f32 v6, v164, v6
    v_add_f32 v6, v165, v6
    v_mfma_f32_16x16x32_bf16 v[84:87], a[244:247], v[210:213], v[84:87]
    s_waitcnt vmcnt(12) lgkmcnt(0)
    v_exp_f32 v166, v166
    v_mfma_f32_16x16x32_bf16 v[64:67], a[240:243], v[204:207], v[64:67]
    s_barrier
    v_mfma_f32_16x16x32_bf16 v[68:71], a[244:247], v[204:207], v[68:71]
    s_mov_b32 m0, s23
    v_mfma_f32_16x16x32_bf16 v[48:51], a[240:243], v[198:201], v[48:51]
    buffer_load_dwordx4 v3, s[8:11], s21 offen offset:0 nt lds
    v_mfma_f32_16x16x32_bf16 v[52:55], a[244:247], v[198:201], v[52:55]
    v_exp_f32 v167, v167
    v_mfma_f32_16x16x32_bf16 v[32:35], a[240:243], v[192:195], v[32:35]
    ds_read_b128 a[224:227], v1 offset:0
    v_add_f32 v6, v166, v6
    v_mfma_f32_16x16x32_bf16 v[36:39], a[244:247], v[192:195], v[36:39]
    v_exp_f32 v168, v168
    v_mfma_f32_16x16x32_bf16 v[16:19], a[240:243], v[186:189], v[16:19]
    buffer_load_dwordx4 v3, s[8:11], s21 offen offset:2048 nt lds
    v_mfma_f32_16x16x32_bf16 v[20:23], a[244:247], v[186:189], v[20:23]
    v_exp_f32 v169, v169
    v_smfmac_f32_16x16x64_bf16 v[8:11], v[252:255], v[210:217], v14
    ds_read_b128 a[228:231], v1 offset:512
    v_add_f32 v6, v167, v6
    v_mfma_f32_16x16x32_bf16 v[24:27], a[248:251], v[186:189], v[24:27]
    v_exp_f32 v170, v170
    v_mfma_f32_16x16x32_bf16 v[28:31], a[252:255], v[186:189], v[28:31]
    s_add_u32 m0, s23, 896
    ds_read_b128 a[232:235], v1 offset:1024
    v_add_f32 v7, v168, v7
    v_mfma_f32_16x16x32_bf16 v[40:43], a[248:251], v[192:195], v[40:43]
    buffer_load_dwordx4 v3, s[8:11], s21 offen offset:128 nt lds
    v_mfma_f32_16x16x32_bf16 v[44:47], a[252:255], v[192:195], v[44:47]
    v_exp_f32 v171, v171
    v_mfma_f32_16x16x32_bf16 v[56:59], a[248:251], v[198:201], v[56:59]
    v_exp_f32 v172, v172
    v_mfma_f32_16x16x32_bf16 v[60:63], a[252:255], v[198:201], v[60:63]
    ds_read_b128 a[236:239], v1 offset:1536
    v_cvt_pk_bf16_f32 v186, v156, v157
    v_mfma_f32_16x16x32_bf16 v[72:75], a[248:251], v[204:207], v[72:75]
    v_exp_f32 v173, v173
    v_mfma_f32_16x16x32_bf16 v[76:79], a[252:255], v[204:207], v[76:79]
    buffer_load_dwordx4 v3, s[8:11], s21 offen offset:2176 nt lds
    v_mfma_f32_16x16x32_bf16 v[88:91], a[248:251], v[210:213], v[88:91]
    v_exp_f32 v174, v174
    v_mfma_f32_16x16x32_bf16 v[92:95], a[252:255], v[210:213], v[92:95]
    v_exp_f32 v175, v175
    v_mfma_f32_16x16x32_bf16 v[104:107], a[248:251], v[216:219], v[104:107]
    v_cvt_pk_bf16_f32 v187, v158, v159
    v_cvt_pk_bf16_f32 v192, v160, v161
    v_mfma_f32_16x16x32_bf16 v[108:111], a[252:255], v[216:219], v[108:111]
    v_exp_f32 v176, v176
    v_mfma_f32_16x16x32_bf16 v[120:123], a[248:251], v[220:223], v[120:123]
    s_sub_u32 s20, s20, 1
    v_cvt_pk_bf16_f32 v193, v162, v163
    v_cvt_pk_bf16_f32 v198, v164, v165
    v_mfma_f32_16x16x32_bf16 v[124:127], a[252:255], v[220:223], v[124:127]
    s_cbranch_scc1 L_tail0
L_Bf:
    s_waitcnt lgkmcnt(3)
    v_mfma_f32_16x16x32_bf16 v[128:131], a[224:227], a[112:115], v[224:227]
    s_waitcnt lgkmcnt(2)
    v_exp_f32 v177, v177
    v_mfma_f32_16x16x32_bf16 v[128:131], a[228:231], a[116:119], v[128:131]
    s_waitcnt lgkmcnt(1)
    ds_read_b64_tr_b16 a[240:241], v2 offset:0
    v_cvt_pk_bf16_f32 v199, v166, v167
    v_mfma_f32_16x16x32_bf16 v[128:131], a[232:235], a[120:123], v[128:131]
    s_waitcnt lgkmcnt(1)
    v_exp_f32 v178, v178
    v_mfma_f32_16x16x32_bf16 v[128:131], a[236:239], a[124:127], v[128:131]
    s_add_u32 s21, s21, 0x4000
    v_exp_f32 v179, v179
    v_mfma_f32_16x16x32_bf16 v[132:135], a[236:239], a[140:143], v[228:231]
    s_add_u32 s56, s56, 0x4000
    ds_read_b64_tr_b16 a[242:243], v2 offset:4096
    v_cvt_pk_bf16_f32 v204, v168, v169
    v_mfma_f32_16x16x32_bf16 v[132:135], a[232:235], a[136:139], v[132:135]
    s_xor_b32 s23, s23, s25
    v_cvt_pk_bf16_f32 v205, v170, v171
    v_cvt_pk_bf16_f32 v210, v172, v173
    v_mfma_f32_16x16x32_bf16 v[132:135], a[228:231], a[132:135], v[132:135]
    s_bitset0_b32 s21, 19
    v_cvt_pk_bf16_f32 v211, v174, v175
    v_cvt_pk_bf16_f32 v216, v176, v177
    v_mfma_f32_16x16x32_bf16 v[132:135], a[224:227], a[128:131], v[132:135]
    s_andn2_b32 s10, 0x80000, s56
    ds_read_b64_tr_b16 a[244:245], v2 offset:256
    v_cvt_pk_bf16_f32 v217, v178, v179
    v_mfma_f32_16x16x32_bf16 v[136:139], a[224:227], a[144:147], v[232:235]
    v_exp_f32 v128, v128
    v_mfma_f32_16x16x32_bf16 v[136:139], a[228:231], a[148:151], v[136:139]
    v_exp_f32 v129, v129
    v_mfma_f32_16x16x32_bf16 v[136:139], a[232:235], a[152:155], v[136:139]
    ds_read_b64_tr_b16 a[246:247], v2 offset:4352
    v_add_f32 v7, v169, v7
    v_mfma_f32_16x16x32_bf16 v[136:139], a[236:239], a[156:159], v[136:139]
    v_exp_f32 v130, v130
    v_mfma_f32_16x16x32_bf16 v[140:143], a[236:239], a[172:175], v[236:239]
    ds_read_b64_tr_b16 a[248:249], v2 offset:512
    v_add_f32 v7, v170, v7
    v_mfma_f32_16x16x32_bf16 v[140:143], a[232:235], a[168:171], v[140:143]
    v_exp_f32 v131, v131
    v_mfma_f32_16x16x32_bf16 v[140:143], a[228:231], a[164:167], v[140:143]
    v_exp_f32 v132, v132
    v_mfma_f32_16x16x32_bf16 v[140:143], a[224:227], a[160:163], v[140:143]
    ds_read_b64_tr_b16 a[250:251], v2 offset:4608
    v_add_f32 v7, v171, v7
    v_mfma_f32_16x16x32_bf16 v[144:147], a[224:227], a[176:179], v[240:243]
    v_exp_f32 v133, v133
    v_mfma_f32_16x16x32_bf16 v[144:147], a[228:231], a[180:183], v[144:147]
    v_exp_f32 v134, v134
    v_mfma_f32_16x16x32_bf16 v[144:147], a[232:235], a[184:187], v[144:147]
    ds_read_b64_tr_b16 a[252:253], v2 offset:768
    v_add_f32 v8, v172, v8
    v_mfma_f32_16x16x32_bf16 v[144:147], a[236:239], a[188:191], v[144:147]
    v_exp_f32 v135, v135
    v_mfma_f32_16x16x32_bf16 v[148:151], a[236:239], a[204:207], v[244:247]
    v_add_f32 v8, v173, v8
    v_add_f32 v8, v174, v8
    v_mfma_f32_16x16x32_bf16 v[148:151], a[232:235], a[200:203], v[148:151]
    ds_read_b64_tr_b16 a[254:255], v2 offset:4864
    v_add_f32 v8, v175, v8
    v_mfma_f32_16x16x32_bf16 v[148:151], a[228:231], a[196:199], v[148:151]
    v_exp_f32 v136, v136
    v_mfma_f32_16x16x32_bf16 v[148:151], a[224:227], a[192:195], v[148:151]
    v_exp_f32 v137, v137
    v_mfma_f32_16x16x32_bf16 v[152:155], a[224:227], a[208:211], v[248:251]
    v_add_f32 v9, v176, v9
    v_add_f32 v9, v177, v9
    v_mfma_f32_16x16x32_bf16 v[152:155], a[228:231], a[212:215], v[152:155]
    v_exp_f32 v138, v138
    v_mfma_f32_16x16x32_bf16 v[152:155], a[232:235], a[216:219], v[152:155]
    s_mov_b32 m0, s24
    v_add_f32 v9, v178, v9
    v_add_f32 v9, v179, v9
    v_mfma_f32_16x16x32_bf16 v[152:155], a[236:239], a[220:223], v[152:155]
    s_waitcnt lgkmcnt(6)
    v_exp_f32 v139, v139
    v_mfma_f32_16x16x32_bf16 a[0:3], a[240:243], v[184:187], a[0:3]
    s_waitcnt lgkmcnt(4)
    v_cvt_pk_bf16_f32 v188, v128, v129
    v_cvt_pk_bf16_f32 v189, v130, v131
    v_mfma_f32_16x16x32_bf16 a[4:7], a[244:247], v[184:187], a[4:7]
    buffer_load_dwordx4 v12, s[12:15], s22 offen offset:0 nt lds
    v_mfma_f32_16x16x32_bf16 a[16:19], a[240:243], v[190:193], a[16:19]
    v_exp_f32 v140, v140
    v_mfma_f32_16x16x32_bf16 a[20:23], a[244:247], v[190:193], a[20:23]
    ds_read_b128 a[224:227], v1 offset:4096
    v_add_f32 v5, v132, v5
    v_mfma_f32_16x16x32_bf16 a[32:35], a[240:243], v[196:199], a[32:35]
    v_exp_f32 v141, v141
    v_mfma_f32_16x16x32_bf16 a[36:39], a[244:247], v[196:199], a[36:39]
    v_exp_f32 v142, v142
    v_mfma_f32_16x16x32_bf16 a[48:51], a[240:243], v[202:205], a[48:51]
    ds_read_b128 a[228:231], v1 offset:4608
    v_cvt_pk_bf16_f32 v194, v132, v133
    v_mfma_f32_16x16x32_bf16 a[52:55], a[244:247], v[202:205], a[52:55]
    buffer_load_dwordx4 v12, s[12:15], s22 offen offset:2048 nt lds
    v_mfma_f32_16x16x32_bf16 a[64:67], a[240:243], v[208:211], a[64:67]
    v_exp_f32 v143, v143
    v_mfma_f32_16x16x32_bf16 a[68:71], a[244:247], v[208:211], a[68:71]
    v_exp_f32 v144, v144
    v_mfma_f32_16x16x32_bf16 a[80:83], a[240:243], v[214:217], a[80:83]
    s_add_u32 m0, s24, s47
    v_add_f32 v5, v133, v5
    v_add_f32 v5, v134, v5
    v_mfma_f32_16x16x32_bf16 a[84:87], a[244:247], v[214:217], a[84:87]
    s_waitcnt lgkmcnt(4)
    ds_read_b128 a[232:235], v1 offset:5120
    v_cvt_pk_bf16_f32 v195, v134, v135
    v_mfma_f32_16x16x32_bf16 a[88:91], a[248:251], v[214:217], a[88:91]
    s_waitcnt lgkmcnt(3)
    v_exp_f32 v145, v145
    v_mfma_f32_16x16x32_bf16 a[92:95], a[252:255], v[214:217], a[92:95]
    buffer_load_dwordx4 v12, s[12:15], s22 offen offset:128 nt lds
    v_mfma_f32_16x16x32_bf16 a[72:75], a[248:251], v[208:211], a[72:75]
    v_exp_f32 v146, v146
    v_mfma_f32_16x16x32_bf16 a[76:79], a[252:255], v[208:211], a[76:79]
    ds_read_b128 a[236:239], v1 offset:5632
    v_add_f32 v5, v135, v5
    v_mfma_f32_16x16x32_bf16 a[56:59], a[248:251], v[202:205], a[56:59]
    v_exp_f32 v147, v147
    v_mfma_f32_16x16x32_bf16 a[60:63], a[252:255], v[202:205], a[60:63]
    v_exp_f32 v148, v148
    v_mfma_f32_16x16x32_bf16 a[40:43], a[248:251], v[196:199], a[40:43]
    v_exp_f32 v149, v149
    v_mfma_f32_16x16x32_bf16 a[44:47], a[252:255], v[196:199], a[44:47]
    buffer_load_dwordx4 v12, s[12:15], s22 offen offset:2176 nt lds
    v_mfma_f32_16x16x32_bf16 a[24:27], a[248:251], v[190:193], a[24:27]
    s_add_u32 s22, s22, 0x4000
    v_exp_f32 v150, v150
    v_mfma_f32_16x16x32_bf16 a[28:31], a[252:255], v[190:193], a[28:31]
    s_add_u32 s57, s57, 0x4000
    v_xor_b32 v1, s25, v1
    v_cvt_pk_bf16_f32 v200, v136, v137
    v_mfma_f32_16x16x32_bf16 a[8:11], a[248:251], v[184:187], a[8:11]
    s_xor_b32 s24, s24, s25
    v_exp_f32 v151, v151
    v_mfma_f32_16x16x32_bf16 a[12:15], a[252:255], v[184:187], a[12:15]
    s_waitcnt lgkmcnt(3)
    v_cvt_pk_bf16_f32 v201, v138, v139
    v_add_f32 v7, v140, v7
    v_mfma_f32_16x16x32_bf16 v[156:159], a[224:227], a[112:115], v[224:227]
    s_waitcnt lgkmcnt(2)
    v_exp_f32 v152, v152
    v_mfma_f32_16x16x32_bf16 v[156:159], a[228:231], a[116:119], v[156:159]
    s_waitcnt lgkmcnt(1)
    ds_read_b64_tr_b16 a[240:241], v2 offset:1024
    v_cvt_pk_bf16_f32 v206, v140, v141
    v_mfma_f32_16x16x32_bf16 v[156:159], a[232:235], a[120:123], v[156:159]
    s_waitcnt lgkmcnt(1)
    v_exp_f32 v153, v153
    v_mfma_f32_16x16x32_bf16 v[156:159], a[236:239], a[124:127], v[156:159]
    s_bitset0_b32 s22, 19
    v_add_f32 v7, v141, v7
    v_add_f32 v7, v142, v7
    v_mfma_f32_16x16x32_bf16 v[160:163], a[236:239], a[140:143], v[228:231]
    s_andn2_b32 s14, 0x80000, s57
    ds_read_b64_tr_b16 a[242:243], v2 offset:5120
    v_cvt_pk_bf16_f32 v207, v142, v143
    v_mfma_f32_16x16x32_bf16 v[160:163], a[232:235], a[136:139], v[160:163]
    v_exp_f32 v154, v154
    v_mfma_f32_16x16x32_bf16 v[160:163], a[228:231], a[132:135], v[160:163]
    ds_read_b64_tr_b16 a[244:245], v2 offset:1280
    v_add_f32 v7, v143, v7
    v_mfma_f32_16x16x32_bf16 v[160:163], a[224:227], a[128:131], v[160:163]
    v_exp_f32 v155, v155
    v_mfma_f32_16x16x32_bf16 v[164:167], a[224:227], a[144:147], v[232:235]
    v_exp_f32 v156, v156
    v_mfma_f32_16x16x32_bf16 v[164:167], a[228:231], a[148:151], v[164:167]
    ds_read_b64_tr_b16 a[246:247], v2 offset:5376
    v_cvt_pk_bf16_f32 v212, v144, v145
    v_mfma_f32_16x16x32_bf16 v[164:167], a[232:235], a[152:155], v[164:167]
    v_exp_f32 v157, v157
    v_mfma_f32_16x16x32_bf16 v[164:167], a[236:239], a[156:159], v[164:167]
    v_cvt_pk_bf16_f32 v213, v146, v147
    v_add_f32 v9, v148, v9
    v_mfma_f32_16x16x32_bf16 v[168:171], a[236:239], a[172:175], v[236:239]
    ds_read_b64_tr_b16 a[248:249], v2 offset:1536
    v_cvt_pk_bf16_f32 v218, v148, v149
    v_mfma_f32_16x16x32_bf16 v[168:171], a[232:235], a[168:171], v[168:171]
    v_exp_f32 v158, v158
    v_mfma_f32_16x16x32_bf16 v[168:171], a[228:231], a[164:167], v[168:171]
    v_exp_f32 v159, v159
    v_mfma_f32_16x16x32_bf16 v[168:171], a[224:227], a[160:163], v[168:171]
    ds_read_b64_tr_b16 a[250:251], v2 offset:5632
    v_add_f32 v9, v149, v9
    v_mfma_f32_16x16x32_bf16 v[172:175], a[224:227], a[176:179], v[240:243]
    v_exp_f32 v160, v160
    v_mfma_f32_16x16x32_bf16 v[172:175], a[228:231], a[180:183], v[172:175]
    ds_read_b64_tr_b16 a[252:253], v2 offset:1792
    v_add_f32 v9, v150, v9
    v_mfma_f32_16x16x32_bf16 v[172:175], a[232:235], a[184:187], v[172:175]
    v_exp_f32 v161, v161
    v_mfma_f32_16x16x32_bf16 v[172:175], a[236:239], a[188:191], v[172:175]
    v_cvt_pk_bf16_f32 v219, v150, v151
    v_add_f32 v9, v151, v9
    v_mfma_f32_16x16x32_bf16 v[176:179], a[236:239], a[204:207], v[244:247]
    ds_read_b64_tr_b16 a[254:255], v2 offset:5888
    v_cvt_pk_bf16_f32 v222, v152, v153
    v_mfma_f32_16x16x32_bf16 v[176:179], a[232:235], a[200:203], v[176:179]
    v_exp_f32 v162, v162
    v_mfma_f32_16x16x32_bf16 v[176:179], a[228:231], a[196:199], v[176:179]
    v_exp_f32 v163, v163
    v_mfma_f32_16x16x32_bf16 v[176:179], a[224:227], a[192:195], v[176:179]
    v_xor_b32 v2, s26, v2
    v_cvt_pk_bf16_f32 v223, v154, v155
    v_mfma_f32_16x16x32_bf16 v[180:183], a[224:227], a[208:211], v[248:251]
    v_exp_f32 v164, v164
    v_mfma_f32_16x16x32_bf16 v[180:183], a[228:231], a[212:215], v[180:183]
    v_add_f32 v10, v152, v10
    v_add_f32 v10, v153, v10
    v_mfma_f32_16x16x32_bf16 v[180:183], a[232:235], a[216:219], v[180:183]
    v_exp_f32 v165, v165
    v_mfma_f32_16x16x32_bf16 v[180:183], a[236:239], a[220:223], v[180:183]
    s_waitcnt lgkmcnt(6)
    v_exp_f32 v166, v166
    v_mfma_f32_16x16x32_bf16 v[96:99], a[240:243], v[214:217], v[96:99]
    s_waitcnt lgkmcnt(4)
    v_add_f32 v10, v154, v10
    v_add_f32 v10, v155, v10
    v_mfma_f32_16x16x32_bf16 v[100:103], a[244:247], v[214:217], v[100:103]
    v_exp_f32 v167, v167
    v_mfma_f32_16x16x32_bf16 v[80:83], a[240:243], v[208:211], v[80:83]
    s_waitcnt vmcnt(12) lgkmcnt(0)
    v_mfma_f32_16x16x32_bf16 v[84:87], a[244:247], v[208:211], v[84:87]
    s_barrier
    v_mfma_f32_16x16x32_bf16 v[64:67], a[240:243], v[202:205], v[64:67]
    v_mfma_f32_16x16x32_bf16 v[68:71], a[244:247], v[202:205], v[68:71]
    v_exp_f32 v168, v168
    v_mfma_f32_16x16x32_bf16 v[48:51], a[240:243], v[196:199], v[48:51]
    s_mov_b32 m0, s23
    ds_read_b128 a[224:227], v1 offset:0
    v_mfma_f32_16x16x32_bf16 v[52:55], a[244:247], v[196:199], v[52:55]
    buffer_load_dwordx4 v3, s[8:11], s21 offen offset:0 nt lds
    v_mfma_f32_16x16x32_bf16 v[32:35], a[240:243], v[190:193], v[32:35]
    v_exp_f32 v169, v169
    v_mfma_f32_16x16x32_bf16 v[36:39], a[244:247], v[190:193], v[36:39]
    ds_read_b128 a[228:231], v1 offset:512
    v_mfma_f32_16x16x32_bf16 v[16:19], a[240:243], v[184:187], v[16:19]
    v_exp_f32 v170, v170
    v_mfma_f32_16x16x32_bf16 v[20:23], a[244:247], v[184:187], v[20:23]
    ds_read_b128 a[232:235], v1 offset:1024
    v_mfma_f32_16x16x32_bf16 v[24:27], a[248:251], v[184:187], v[24:27]
    v_exp_f32 v171, v171
    v_mfma_f32_16x16x32_bf16 v[28:31], a[252:255], v[184:187], v[28:31]
    buffer_load_dwordx4 v3, s[8:11], s21 offen offset:2048 nt lds
    v_mfma_f32_16x16x32_bf16 v[40:43], a[248:251], v[190:193], v[40:43]
    ds_read_b128 a[236:239], v1 offset:1536
    v_cvt_pk_bf16_f32 v186, v156, v157
    v_mfma_f32_16x16x32_bf16 v[44:47], a[252:255], v[190:193], v[44:47]
    s_add_u32 m0, s23, 896
    v_exp_f32 v172, v172
    v_mfma_f32_16x16x32_bf16 v[56:59], a[248:251], v[196:199], v[56:59]
    buffer_load_dwordx4 v3, s[8:11], s21 offen offset:128 nt lds
    v_mfma_f32_16x16x32_bf16 v[60:63], a[252:255], v[196:199], v[60:63]
    v_exp_f32 v173, v173
    v_mfma_f32_16x16x32_bf16 v[72:75], a[248:251], v[202:205], v[72:75]
    v_exp_f32 v174, v174
    v_mfma_f32_16x16x32_bf16 v[76:79], a[252:255], v[202:205], v[76:79]
    v_exp_f32 v175, v175
    v_mfma_f32_16x16x32_bf16 v[88:91], a[248:251], v[208:211], v[88:91]
    v_exp_f32 v176, v176
    v_mfma_f32_16x16x32_bf16 v[92:95], a[252:255], v[208:211], v[92:95]
    buffer_load_dwordx4 v3, s[8:11], s21 offen offset:2176 nt lds
    v_mfma_f32_16x16x32_bf16 v[104:107], a[248:251], v[214:217], v[104:107]
    s_sub_u32 s20, s20, 1
    v_exp_f32 v177, v177
    v_mfma_f32_16x16x32_bf16 v[108:111], a[252:255], v[214:217], v[108:111]
    s_cbranch_scc0 L_Af
    s_branch L_tail1
.section .rodata,"a"
.p2align 6
.amdhsa_kernel standalone__gqa_softmax__near_ridge_kernel
  .amdhsa_next_free_vgpr 512
  .amdhsa_next_free_sgpr 102
  .amdhsa_accum_offset 256
  .amdhsa_group_segment_fixed_size 0
  .amdhsa_kernarg_size 48
  .amdhsa_user_sgpr_count 2
  .amdhsa_user_sgpr_kernarg_segment_ptr 1
  .amdhsa_system_sgpr_workgroup_id_x 1
.end_amdhsa_kernel
```
